```python
import torch

def _softmax(x, axis=-1):
    return torch.softmax(x, dim=axis)
def _gelu(x):
    return torch.nn.functional.gelu(x, approximate="tanh")
def _silu(x):
    return torch.nn.functional.silu(x)
def _sigmoid(x):
    return torch.sigmoid(x)
def _layernorm(x, axis=-1, eps=1e-5):
    m = x.mean(dim=axis, keepdim=True)
    v = x.var(dim=axis, keepdim=True, unbiased=False)
    return (x - m) / torch.sqrt(v + eps)
def _scatter_add(tgt, idx, src, axis=0):
    return tgt.clone().index_add_(axis, idx, src)
def _segment_sum(src, seg, n):
    out = torch.zeros((n,) + src.shape[1:], dtype=src.dtype)
    return out.index_add_(0, seg, src)
def _pad(x, pw):
    flat = tuple(v for pair in reversed(pw) for v in pair)
    return torch.nn.functional.pad(x, flat)

kernel_name = 'recurrent_scan__spectral_fnet__mixer_token_mlp__prompt'

def setup_inputs():

    _w = (lambda a: (lambda t: t.to(torch.bfloat16) if t.is_floating_point() else t)(torch.as_tensor(a)))
    def _A_setup():
        B, S, D = 1, 2048, 512
        ns = torch.arange(S)[:, None] * torch.arange(S)[None, :]
        nd = torch.arange(D)[:, None] * torch.arange(D)[None, :]
        Ws_re = torch.cos(-2.0 * torch.pi * ns / S).to(float)
        Ws_im = torch.sin(-2.0 * torch.pi * ns / S).to(float)
        Wd_re = torch.cos(-2.0 * torch.pi * nd / D).to(float)
        Wd_im = torch.sin(-2.0 * torch.pi * nd / D).to(float)
        return {
            "x": _w((lambda *s: torch.randn(*s, dtype=torch.bfloat16) * 0.05)(B, S, D)),
            "dft_seq_re": _w(Ws_re),
            "dft_seq_im": _w(Ws_im),
            "dft_hid_re": _w(Wd_re),
            "dft_hid_im": _w(Wd_im),
        }
    _A_in = _A_setup()

    def _B_setup():
        B, S, D, F = 1, 2048, 512, 1792
        return {
            "x": _w((lambda *s: torch.randn(*s, dtype=torch.bfloat16) * 0.05)(B, S, D)),
            "w1": _w((lambda *s: torch.randn(*s, dtype=torch.bfloat16) * 0.2)(S, F) * (S ** -0.5)),
            "b1": _w((lambda *s: torch.randn(*s, dtype=torch.bfloat16) * 3.2)(F) * 0.02),
            "w2": _w((lambda *s: torch.randn(*s, dtype=torch.bfloat16) * 0.05)(F, S) * (F ** -0.5)),
            "b2": _w((lambda *s: torch.randn(*s, dtype=torch.bfloat16) * 0.05)(S) * 0.02),
        }
    _B_in = _B_setup()

    return {
        "A_x": _A_in["x"],
        "A_dft_seq_re": _A_in["dft_seq_re"],
        "A_dft_seq_im": _A_in["dft_seq_im"],
        "A_dft_hid_re": _A_in["dft_hid_re"],
        "A_dft_hid_im": _A_in["dft_hid_im"],
        "B_x": _B_in["x"],
        "B_w1": _B_in["w1"],
        "B_b1": _B_in["b1"],
        "B_w2": _B_in["w2"],
        "B_b2": _B_in["b2"],
    }

def reference(A_x, A_dft_seq_re, A_dft_seq_im, A_dft_hid_re, A_dft_hid_im, B_x, B_w1, B_b1, B_w2, B_b2):
    def _A_ref(x, dft_seq_re, dft_seq_im, dft_hid_re, dft_hid_im):
        a = torch.einsum("bsd,ed->bse", x, dft_hid_re)
        b = torch.einsum("bsd,ed->bse", x, dft_hid_im)
        y = torch.einsum("ts,bse->bte", dft_seq_re, a) - torch.einsum("ts,bse->bte", dft_seq_im, b)
        return y

    def _B_ref(x, w1, b1, w2, b2):
        B, S, D = x.shape
        h = _layernorm(x, axis=-1)
        u = torch.einsum("bsd,sf->bdf", h, w1) + b1
        u = _gelu(u)
        y = torch.einsum("bdf,fs->bds", u, w2) + b2
        return (lambda x, *d: x.permute(*d))(y, 0, 2, 1)

    x = A_x
    xn = _layernorm(x, axis=-1)
    s = _A_ref(xn, A_dft_seq_re, A_dft_seq_im, A_dft_hid_re, A_dft_hid_im)
    g = _silu(_B_ref(xn, B_w1, B_b1, B_w2, B_b2))
    return x + s * g
```

```asm
; @launch grid=(256,1,1) block=(256,1,1) lds=163840
.amdgcn_target "amdgcn-amd-amdhsa--gfx950"
.text
.globl recurrent_scan__spectral_fnet__mixer_token_mlp__prompt_kernel
.p2align 8
.type recurrent_scan__spectral_fnet__mixer_token_mlp__prompt_kernel,@function
recurrent_scan__spectral_fnet__mixer_token_mlp__prompt_kernel:
    s_cmp_ge_u32 s2, 256
    s_cbranch_scc1 L_end
    s_load_dwordx2 s[4:5], s[0:1], 0
    s_getpc_b64 s[32:33]
L_pc:
    s_mov_b32 s34, L_code_end-L_pc
    s_mov_b32 s35, 0x20000
    s_lshr_b32 s76, s2, 3
    s_lshl_b32 s76, s76, 11
    v_lshrrev_b32 v40, 4, v0
    v_lshlrev_b32 v40, 7, v40
    buffer_load_dword v33, v40, s[32:35], s76 offen
    s_load_dwordx2 s[16:17], s[0:1], 96
    s_load_dwordx2 s[8:9], s[0:1], 48
    s_load_dwordx2 s[12:13], s[0:1], 64
    s_load_dwordx2 s[24:25], s[0:1], 56
    s_load_dwordx2 s[28:29], s[0:1], 72
    s_load_dwordx2 s[20:21], s[0:1], 80
    v_mov_b32 v3, 0
    v_lshrrev_b32 v40, 6, v0
    v_and_b32 v1, 63, v0
    v_readfirstlane_b32 s36, v40
    v_lshlrev_b32 v41, 4, v1
    v_lshl_add_u32 v41, v40, 17, v41
    s_lshr_b32 s76, s2, 6
    s_lshl_b32 s76, s76, 19
    s_and_b32 s77, s2, 63
    s_lshl_b32 s77, s77, 10
    s_add_u32 s60, s76, s77
    s_add_u32 s61, s60, 65536
    s_mov_b32 s6, 2097152
    s_mov_b32 s7, 0x20000
    s_mov_b32 s10, 7340032
    s_mov_b32 s11, 0x20000
    s_mov_b32 s14, 7340032
    s_mov_b32 s15, 0x20000
    s_mov_b32 s18, 10223616
    s_mov_b32 s19, 0x20000
    s_mov_b32 s22, 2097152
    s_mov_b32 s23, 0x20000
    s_mov_b32 s26, 3584
    s_mov_b32 s27, 0x20000
    s_mov_b32 s30, 4096
    s_mov_b32 s31, 0x20000
    s_lshr_b32 s41, s2, 5
    s_bfe_u32 s77, s2, 0x20003
    s_and_b32 s76, s2, 7
    s_lshl2_add_u32 s40, s76, s77
    s_min_u32 s64, s41, 6
    s_lshr_b32 s76, s76, 1
    s_mul_i32 s39, s76, 7
    s_and_b32 s76, s2, 1
    s_lshl_b32 s76, s76, 2
    s_lshr_b32 s78, s2, 6
    s_add_u32 s43, s76, s78
    s_add_u32 s76, s76, s77
    s_and_b32 s38, s41, 1
    s_lshl1_add_u32 s77, s77, s38
    s_bfe_u32 s38, s2, 0x30003
    s_cmp_eq_u32 s78, 3
    s_cselect_b32 s43, 3, s43
    s_cselect_b32 s44, s77, s38
    s_cselect_b32 s38, s76, s38
    s_add_u32 s39, s39, s43
    s_lshl_b32 s42, s36, 15
    s_lshl_b32 s79, s36, 5
    s_and_b32 s79, s79, 64
    s_bfe_u32 s43, s2, 0x40003
    s_mov_b32 s78, 0
    s_cmp_ge_u32 s43, 1
    s_cselect_b32 s78, 1, s78
    s_cmp_ge_u32 s43, 5
    s_cselect_b32 s78, 5, s78
    s_cmp_ge_u32 s43, 9
    s_cselect_b32 s78, 9, s78
    s_cmp_ge_u32 s43, 14
    s_cselect_b32 s78, 14, s78
    s_cmp_ge_u32 s43, 15
    s_cselect_b32 s78, 15, s78
    s_sub_u32 s78, s43, s78
    s_mul_i32 s78, s78, 0x218000
    s_add_u32 s34, s78, 4
    s_waitcnt lgkmcnt(0)
    s_mov_b64 s[32:33], s[4:5]
    s_cmp_ge_u32 s43, 1
    s_cselect_b64 s[32:33], s[8:9], s[32:33]
    s_cmp_ge_u32 s43, 5
    s_cselect_b64 s[32:33], s[12:13], s[32:33]
    s_cmp_ge_u32 s43, 9
    s_cselect_b64 s[32:33], s[16:17], s[32:33]
    s_cmp_ge_u32 s43, 14
    s_cselect_b64 s[32:33], s[24:25], s[32:33]
    s_cmp_ge_u32 s43, 15
    s_cselect_b64 s[32:33], s[28:29], s[32:33]
    buffer_load_dword v63, v3, s[32:35], s78 offen
    buffer_load_dwordx4 v[64:67], v41, s[4:7], s60 offen
    buffer_load_dwordx4 v[68:71], v41, s[4:7], s61 offen
    buffer_load_dword v2, v3, s[16:19], 0 offen sc1
    v_lshrrev_b32 v42, 3, v1
    v_and_b32 v43, 7, v1
    v_and_b32 v44, 2, v42
    v_xor_b32 v43, v43, v44
    s_mul_i32 s76, s36, 1835008
    s_lshl_b32 s78, s39, 7
    v_mul_u32_u24 v44, 229376, v42
    s_mov_b32 s48, s44
    s_add_u32 s76, s76, s78
    v_lshl_add_u32 v44, v43, 4, v44
    v_add_u32 v4, s76, v44
    s_mov_b32 s49, 8
    s_mov_b32 s50, 28672
    s_mov_b32 s51, 14336
    v_xor_b32 v44, 64, v4
    v_add_u32 v5, 2560, v44
    v_add_u32 v6, 5120, v4
    v_add_u32 v7, 7680, v44
    s_lshl2_add_u32 s76, s40, s36
    s_lshl_b32 s76, s76, 5
    v_and_b32 v41, 15, v1
    v_lshl_add_u32 v41, v41, 1, s76
    s_lshl_b32 s76, s41, 7
    v_lshrrev_b32 v42, 4, v1
    buffer_load_ushort v37, v41, s[28:31], 0 offen
    v_lshl_add_u32 v36, v42, 4, s76
    v_lshl_add_u32 v36, v41, 9, v36
    s_lshr_b32 s76, s36, 1
    s_lshl1_add_u32 s76, s39, s76
    s_lshl_b32 s76, s76, 6
    v_lshlrev_b32 v42, 3, v42
    buffer_load_dwordx2 v[28:29], v42, s[24:27], s76 offen
    buffer_load_dwordx2 v[30:31], v42, s[24:27], s76 offen offset:32
    v_and_b32 v42, 15, v1
    v_lshrrev_b32 v43, 4, v1
    v_cvt_f32_ubyte0 v44, v42
    v_cvt_f32_ubyte0 v45, v43
    v_mul_f32 v45, 4.0, v45
    v_cmp_eq_u32 s[90:91], 0, v42
    v_cmp_lt_u32 s[92:93], 7, v42
    v_mul_f32 v48, 0x3d000000, v44
    v_mul_f32 v96, v45, v48
    v_fmamk_f32 v97, v48, 0x3f800000, v96
    v_fmamk_f32 v98, v48, 0x40000000, v96
    v_fmamk_f32 v99, v48, 0x40400000, v96
    v_fmamk_f32 v100, v48, 0x41800000, v96
    v_fmamk_f32 v101, v48, 0x41880000, v96
    v_fmamk_f32 v102, v48, 0x41900000, v96
    v_fmamk_f32 v103, v48, 0x41980000, v96
    v_cos_f32 v104, v96
    v_sin_f32 v112, v96
    v_cos_f32 v105, v97
    v_sin_f32 v113, v97
    v_cos_f32 v106, v98
    v_sin_f32 v114, v98
    v_cos_f32 v107, v99
    v_sin_f32 v115, v99
    v_cos_f32 v108, v100
    s_add_u32 m0, s42, 0
    s_mul_i32 s46, s48, s50
    buffer_load_dwordx4 v4, s[8:11], s46 offen offset:0 lds
    s_add_u32 s48, s48, 1
    s_cmp_eq_u32 s48, s49
    s_cselect_b32 s48, 0, s48
    v_sin_f32 v116, v100
    v_cos_f32 v109, v101
    v_sin_f32 v117, v101
    v_cos_f32 v110, v102
    v_sin_f32 v118, v102
    v_cos_f32 v111, v103
    v_sin_f32 v119, v103
    v_mov_b32 v47, 0xbf803f80
    v_cvt_pk_bf16_f32 v128, v104, v105
    v_cvt_pk_bf16_f32 v132, -v112, -v113
    v_cndmask_b32 v132, v132, v47, s[90:91]
    v_cvt_pk_bf16_f32 v129, v106, v107
    v_cvt_pk_bf16_f32 v133, -v114, -v115
    v_cndmask_b32 v133, v133, v47, s[90:91]
    v_cvt_pk_bf16_f32 v130, v108, v109
    v_cvt_pk_bf16_f32 v134, -v116, -v117
    v_cndmask_b32 v134, v134, v47, s[90:91]
    v_cvt_pk_bf16_f32 v131, v110, v111
    v_cvt_pk_bf16_f32 v135, -v118, -v119
    v_cndmask_b32 v135, v135, v47, s[90:91]
    v_mul_f32 v48, 0x3b000000, v44
    v_mul_f32 v96, v45, v48
    v_fmamk_f32 v97, v48, 0x3f800000, v96
    v_fmamk_f32 v98, v48, 0x40000000, v96
    v_fmamk_f32 v99, v48, 0x40400000, v96
    v_cos_f32 v136, v96
    v_sin_f32 v140, v96
    v_cos_f32 v137, v97
    v_sin_f32 v141, v97
    v_cos_f32 v138, v98
    v_sin_f32 v142, v98
    v_cos_f32 v139, v99
    v_sin_f32 v143, v99
    v_mul_f32 v48, 0x3d800000, v44
    v_mul_f32 v96, v45, v48
    v_fmamk_f32 v97, v48, 0x3f800000, v96
    v_fmamk_f32 v98, v48, 0x40000000, v96
    v_fmamk_f32 v99, v48, 0x40400000, v96
    v_cos_f32 v104, v96
    v_sin_f32 v112, v96
    buffer_load_dwordx4 v5, s[8:11], s46 offen offset:1024 lds
    v_cos_f32 v105, v97
    v_sin_f32 v113, v97
    v_cos_f32 v106, v98
    v_sin_f32 v114, v98
    v_cos_f32 v107, v99
    v_sin_f32 v115, v99
    v_mov_b32 v47, 0x80008000
    v_cndmask_b32 v47, 0, v47, s[92:93]
    v_cvt_pk_bf16_f32 v144, v104, v105
    v_cvt_pk_bf16_f32 v146, v112, v113
    v_cvt_pk_bf16_f32 v148, -v112, -v113
    v_xor_b32 v148, v148, v47
    v_xor_b32 v150, v144, v47
    v_cvt_pk_bf16_f32 v145, v106, v107
    v_cvt_pk_bf16_f32 v147, v114, v115
    v_cvt_pk_bf16_f32 v149, -v114, -v115
    v_xor_b32 v149, v149, v47
    v_xor_b32 v151, v145, v47
    v_add_f32 v96, 0x3d800000, v48
    v_add_f32 v97, 0xbef00000, v48
    v_cndmask_b32 v48, v96, v97, s[92:93]
    v_mul_f32 v96, v45, v48
    v_fmamk_f32 v97, v48, 0x3f800000, v96
    v_fmamk_f32 v98, v48, 0x40000000, v96
    v_fmamk_f32 v99, v48, 0x40400000, v96
    v_cos_f32 v104, v96
    v_sin_f32 v112, v96
    v_cos_f32 v105, v97
    v_sin_f32 v113, v97
    v_cos_f32 v106, v98
    v_sin_f32 v114, v98
    v_cos_f32 v107, v99
    v_sin_f32 v115, v99
    v_cvt_pk_bf16_f32 v96, v104, v105
    v_cvt_pk_bf16_f32 v98, -v112, -v113
    v_cvt_pk_bf16_f32 v97, v106, v107
    v_cvt_pk_bf16_f32 v99, -v114, -v115
    v_cmp_eq_u32 vcc, 7, v42
    v_mov_b32 v47, 0x3f803f80
    s_nop 0
    v_cndmask_b32 v98, v98, v47, vcc
    buffer_load_dwordx4 v6, s[8:11], s46 offen offset:2048 lds
    v_cndmask_b32 v99, v99, v47, vcc
    v_cndmask_b32 v152, v96, 0, s[92:93]
    v_cndmask_b32 v154, 0, v96, s[92:93]
    v_cndmask_b32 v156, v98, 0, s[92:93]
    v_cndmask_b32 v158, 0, v98, s[92:93]
    v_cndmask_b32 v153, v97, 0, s[92:93]
    v_cndmask_b32 v155, 0, v97, s[92:93]
    v_cndmask_b32 v157, v99, 0, s[92:93]
    v_cndmask_b32 v159, 0, v99, s[92:93]
    s_mul_i32 s76, s36, 2176
    s_add_u32 s76, s76, 131072
    v_lshl_add_u32 v56, v1, 4, s76
    v_bfe_u32 v40, v1, 2, 2
    v_mul_u32_u24 v40, 1088, v40
    v_lshrrev_b32 v41, 4, v1
    v_lshl_add_u32 v40, v41, 5, v40
    v_and_b32 v41, 3, v1
    v_lshl_add_u32 v40, v41, 3, v40
    s_lshl_b32 s76, s36, 8
    s_add_u32 s76, s76, 139776
    v_add_u32 v57, s76, v40
    v_lshrrev_b32 v40, 5, v1
    v_mul_u32_u24 v40, 131072, v40
    v_lshl_add_u32 v40, v41, 4, v40
    v_bfe_u32 v41, v1, 2, 1
    v_lshl_add_u32 v40, v41, 10, v40
    v_bfe_u32 v41, v1, 3, 2
    v_lshl_add_u32 v58, v41, 6, v40
    s_lshl_b32 s76, s36, 19
    s_and_b32 s77, s2, 3
    s_add_u32 s78, s2, s2
    s_sub_u32 s77, s78, s77
    s_lshl_b32 s77, s77, 8
    s_mul_i32 s78, s36, 524288
    s_add_u32 s77, s78, s77
    s_add_u32 s60, s77, 2199552
    s_add_u32 s61, s77, 2461696
    s_lshl_b32 s77, s2, 6
    s_add_u32 s77, s76, s77
    s_add_u32 s62, s77, 4395008
    buffer_load_dwordx4 v7, s[8:11], s46 offen offset:3072 lds
    s_add_u32 s63, s77, 4657152
    s_lshl_b32 s76, s36, 8
    s_add_u32 s76, s76, s2
    s_lshl_b32 s56, s76, 4
    s_lshl_b32 s57, s76, 4
    s_add_u32 s56, s56, 65536
    s_add_u32 s57, s57, 196608
    v_lshlrev_b32 v40, 3, v1
    v_sub_u32 v61, v56, v40
    s_waitcnt vmcnt(7)
    v_readfirstlane_b32 s37, v2
    s_nop 0
    s_mul_i32 s37, s37, 0x9e3779b1
    s_add_u32 s37, s37, 0x7f4a7c15
    v_mov_b32 v2, s37
    s_lshr_b32 s76, s2, 3
    s_and_b32 s76, s76, 19
    s_cmp_lg_u32 s76, s36
    s_cbranch_scc1 L_nocnt_1
    s_lshl_b32 s76, s2, 7
    s_add_u32 s76, s76, 327680
    s_mov_b32 s94, s37
    s_atomic_swap s94, s[16:17], s76 glc
L_nocnt_1:
    v_lshlrev_b32 v72, 16, v64
    v_and_b32 v73, 0xffff0000, v64
    v_lshlrev_b32 v74, 16, v65
    v_and_b32 v75, 0xffff0000, v65
    v_lshlrev_b32 v76, 16, v66
    v_and_b32 v77, 0xffff0000, v66
    v_lshlrev_b32 v78, 16, v67
    v_and_b32 v79, 0xffff0000, v67
    v_lshlrev_b32 v80, 16, v68
    v_and_b32 v81, 0xffff0000, v68
    v_lshlrev_b32 v82, 16, v69
    v_and_b32 v83, 0xffff0000, v69
    v_lshlrev_b32 v84, 16, v70
    v_and_b32 v85, 0xffff0000, v70
    v_lshlrev_b32 v86, 16, v71
    v_and_b32 v87, 0xffff0000, v71
    v_readlane_b32 s80, v72, 0
    v_readlane_b32 s81, v80, 0
    v_and_b32 v120, 15, v1
    v_lshrrev_b32 v121, 4, v1
    v_pk_add_f32 v[96:97], v[72:73], s[80:81] op_sel_hi:[1,0] neg_lo:[0,1] neg_hi:[0,1]
    v_pk_add_f32 v[104:105], v[80:81], s[80:81] op_sel:[0,1] op_sel_hi:[1,1] neg_lo:[0,1] neg_hi:[0,1]
    v_pk_add_f32 v[98:99], v[74:75], s[80:81] op_sel_hi:[1,0] neg_lo:[0,1] neg_hi:[0,1]
    v_pk_add_f32 v[106:107], v[82:83], s[80:81] op_sel:[0,1] op_sel_hi:[1,1] neg_lo:[0,1] neg_hi:[0,1]
    v_pk_add_f32 v[100:101], v[76:77], s[80:81] op_sel_hi:[1,0] neg_lo:[0,1] neg_hi:[0,1]
    v_pk_add_f32 v[108:109], v[84:85], s[80:81] op_sel:[0,1] op_sel_hi:[1,1] neg_lo:[0,1] neg_hi:[0,1]
    v_pk_add_f32 v[102:103], v[78:79], s[80:81] op_sel_hi:[1,0] neg_lo:[0,1] neg_hi:[0,1]
    v_pk_add_f32 v[110:111], v[86:87], s[80:81] op_sel:[0,1] op_sel_hi:[1,1] neg_lo:[0,1] neg_hi:[0,1]
    v_pk_add_f32 v[40:41], v[96:97], v[98:99]
    s_add_u32 m0, s42, 4096
    s_add_u32 s46, s46, s51
    buffer_load_dwordx4 v4, s[8:11], s46 offen offset:0 lds
    v_pk_mul_f32 v[44:45], v[96:97], v[96:97]
    v_pk_add_f32 v[42:43], v[100:101], v[102:103]
    v_pk_mul_f32 v[46:47], v[100:101], v[100:101]
    v_pk_add_f32 v[48:49], v[104:105], v[106:107]
    v_pk_mul_f32 v[52:53], v[104:105], v[104:105]
    v_pk_add_f32 v[50:51], v[108:109], v[110:111]
    v_pk_mul_f32 v[54:55], v[108:109], v[108:109]
    v_pk_fma_f32 v[44:45], v[98:99], v[98:99], v[44:45]
    v_pk_fma_f32 v[46:47], v[102:103], v[102:103], v[46:47]
    v_pk_add_f32 v[40:41], v[40:41], v[42:43]
    v_pk_fma_f32 v[52:53], v[106:107], v[106:107], v[52:53]
    v_pk_fma_f32 v[54:55], v[110:111], v[110:111], v[54:55]
    v_pk_add_f32 v[48:49], v[48:49], v[50:51]
    v_pk_add_f32 v[44:45], v[44:45], v[46:47]
    v_add_f32 v40, v40, v41
    v_pk_add_f32 v[52:53], v[52:53], v[54:55]
    v_add_f32 v48, v48, v49
    v_add_f32 v44, v44, v45
    v_add_f32 v52, v52, v53
    v_permlane32_swap_b32 v40, v48
    v_cmp_lt_u32 s[92:93], 1, v121
    v_permlane32_swap_b32 v44, v52
    v_add_f32 v40, v40, v48
    v_add_f32 v44, v44, v52
    v_lshl_add_u32 v122, v121, 7, v120
    s_andn2_b64 vcc, s[92:93], s[90:91]
    v_permlane16_swap_b32 v40, v44
    v_add_f32 v40, v40, v44
    v_sub_u32 v123, 512, v122
    v_mov_b32 v124, 1152
    v_add_f32_dpp v40, v40, v40 quad_perm:[1,0,3,2] row_mask:0xf bank_mask:0xf
    v_cndmask_b32 v123, v122, v123, vcc
    v_sub_u32 v120, 0, v124
    v_add_f32_dpp v40, v40, v40 quad_perm:[2,3,0,1] row_mask:0xf bank_mask:0xf
    v_cndmask_b32 v124, v124, v120, vcc
    v_mov_b32 v120, -240
    v_add_f32_dpp v40, v40, v40 row_half_mirror row_mask:0xf bank_mask:0xf
    v_cndmask_b32 v120, 32, v120, s[92:93]
    v_cndmask_b32 v120, 0, v120, s[90:91]
    v_add_f32_dpp v40, v40, v40 row_mirror row_mask:0xf bank_mask:0xf
    v_mov_b32 v44, v40
    v_add_u32 v122, v123, v120
    s_lshl_b32 s76, s36, 3
    v_permlane16_swap_b32 v40, v44
    v_mul_f32 v40, 0x3b000000, v40
    v_mul_f32 v44, 0x3b000000, v44
    v_fma_f32 v44, -v40, v40, v44
    v_max_f32 v44, 0, v44
    v_mov_b32 v48, s80
    v_mov_b32 v52, s81
    v_lshrrev_b32 v123, 2, v122
    s_add_u32 s76, s76, 148480
    v_permlane32_swap_b32 v48, v52
    v_add_f32 v40, v40, v48
    v_cvt_pk_bf16_f32 v44, 0, v44
    buffer_load_dwordx4 v5, s[8:11], s46 offen offset:1024 lds
    v_cvt_pk_bf16_f32 v40, 0, v40
    v_add_f32 v44, 0x3727c5ac, v44
    v_cvt_pk_bf16_f32 v44, 0, v44
    v_sqrt_f32 v44, v44
    v_readlane_b32 s80, v40, 0
    v_cvt_pk_bf16_f32 v44, 0, v44
    v_rcp_f32 v44, v44
    v_readlane_b32 s81, v40, 32
    v_readlane_b32 s82, v44, 0
    v_readlane_b32 s83, v44, 32
    v_pk_add_f32 v[72:73], v[72:73], s[80:81] op_sel_hi:[1,0] neg_lo:[0,1] neg_hi:[0,1]
    v_pk_add_f32 v[80:81], v[80:81], s[80:81] op_sel:[0,1] op_sel_hi:[1,1] neg_lo:[0,1] neg_hi:[0,1]
    v_pk_add_f32 v[74:75], v[74:75], s[80:81] op_sel_hi:[1,0] neg_lo:[0,1] neg_hi:[0,1]
    v_pk_add_f32 v[82:83], v[82:83], s[80:81] op_sel:[0,1] op_sel_hi:[1,1] neg_lo:[0,1] neg_hi:[0,1]
    v_pk_add_f32 v[76:77], v[76:77], s[80:81] op_sel_hi:[1,0] neg_lo:[0,1] neg_hi:[0,1]
    v_pk_add_f32 v[84:85], v[84:85], s[80:81] op_sel:[0,1] op_sel_hi:[1,1] neg_lo:[0,1] neg_hi:[0,1]
    v_pk_add_f32 v[78:79], v[78:79], s[80:81] op_sel_hi:[1,0] neg_lo:[0,1] neg_hi:[0,1]
    v_pk_add_f32 v[86:87], v[86:87], s[80:81] op_sel:[0,1] op_sel_hi:[1,1] neg_lo:[0,1] neg_hi:[0,1]
    v_cvt_pk_bf16_f32 v72, 0, v72
    v_cvt_pk_bf16_f32 v80, 0, v80
    v_cvt_pk_bf16_f32 v73, 0, v73
    v_cvt_pk_bf16_f32 v81, 0, v81
    v_cvt_pk_bf16_f32 v74, 0, v74
    v_cvt_pk_bf16_f32 v82, 0, v82
    v_cvt_pk_bf16_f32 v75, 0, v75
    v_cvt_pk_bf16_f32 v83, 0, v83
    v_cvt_pk_bf16_f32 v76, 0, v76
    v_cvt_pk_bf16_f32 v84, 0, v84
    v_cvt_pk_bf16_f32 v77, 0, v77
    v_cvt_pk_bf16_f32 v85, 0, v85
    v_cvt_pk_bf16_f32 v78, 0, v78
    v_cvt_pk_bf16_f32 v86, 0, v86
    v_cvt_pk_bf16_f32 v79, 0, v79
    v_cvt_pk_bf16_f32 v87, 0, v87
    v_pk_mul_f32 v[72:73], v[72:73], s[82:83] op_sel_hi:[1,0]
    v_pk_mul_f32 v[80:81], v[80:81], s[82:83] op_sel:[0,1] op_sel_hi:[1,1]
    v_pk_mul_f32 v[74:75], v[74:75], s[82:83] op_sel_hi:[1,0]
    v_pk_mul_f32 v[82:83], v[82:83], s[82:83] op_sel:[0,1] op_sel_hi:[1,1]
    v_pk_mul_f32 v[76:77], v[76:77], s[82:83] op_sel_hi:[1,0]
    v_pk_mul_f32 v[84:85], v[84:85], s[82:83] op_sel:[0,1] op_sel_hi:[1,1]
    buffer_load_dwordx4 v6, s[8:11], s46 offen offset:2048 lds
    v_pk_mul_f32 v[78:79], v[78:79], s[82:83] op_sel_hi:[1,0]
    v_pk_mul_f32 v[86:87], v[86:87], s[82:83] op_sel:[0,1] op_sel_hi:[1,1]
    v_cvt_pk_bf16_f32 v64, v72, v73
    v_cvt_pk_bf16_f32 v68, v80, v81
    v_cvt_pk_bf16_f32 v65, v74, v75
    v_cvt_pk_bf16_f32 v69, v82, v83
    v_cvt_pk_bf16_f32 v66, v76, v77
    v_cvt_pk_bf16_f32 v70, v84, v85
    v_cvt_pk_bf16_f32 v67, v78, v79
    v_cvt_pk_bf16_f32 v71, v86, v87
    ds_write_b128 v56, v[64:67]
    ds_write_b128 v56, v[68:71] offset:1088
    v_lshlrev_b32 v72, 16, v64
    v_and_b32 v73, 0xffff0000, v64
    v_lshlrev_b32 v74, 16, v65
    v_and_b32 v75, 0xffff0000, v65
    v_lshlrev_b32 v76, 16, v66
    v_and_b32 v77, 0xffff0000, v66
    v_lshlrev_b32 v78, 16, v67
    v_and_b32 v79, 0xffff0000, v67
    v_lshlrev_b32 v80, 16, v68
    v_and_b32 v81, 0xffff0000, v68
    v_lshlrev_b32 v82, 16, v69
    v_and_b32 v83, 0xffff0000, v69
    v_lshlrev_b32 v84, 16, v70
    v_and_b32 v85, 0xffff0000, v70
    v_lshlrev_b32 v86, 16, v71
    v_and_b32 v87, 0xffff0000, v71
    v_pk_add_f32 v[40:41], v[72:73], v[74:75]
    v_pk_mul_f32 v[44:45], v[72:73], v[72:73]
    v_pk_add_f32 v[42:43], v[76:77], v[78:79]
    v_pk_mul_f32 v[46:47], v[76:77], v[76:77]
    v_pk_add_f32 v[48:49], v[80:81], v[82:83]
    v_pk_mul_f32 v[52:53], v[80:81], v[80:81]
    v_pk_add_f32 v[50:51], v[84:85], v[86:87]
    v_pk_mul_f32 v[54:55], v[84:85], v[84:85]
    v_pk_fma_f32 v[44:45], v[74:75], v[74:75], v[44:45]
    v_pk_fma_f32 v[46:47], v[78:79], v[78:79], v[46:47]
    v_pk_add_f32 v[40:41], v[40:41], v[42:43]
    v_pk_fma_f32 v[52:53], v[82:83], v[82:83], v[52:53]
    buffer_load_dwordx4 v7, s[8:11], s46 offen offset:3072 lds
    v_pk_fma_f32 v[54:55], v[86:87], v[86:87], v[54:55]
    v_pk_add_f32 v[48:49], v[48:49], v[50:51]
    v_pk_add_f32 v[44:45], v[44:45], v[46:47]
    v_add_f32 v40, v40, v41
    v_pk_add_f32 v[52:53], v[52:53], v[54:55]
    v_add_f32 v48, v48, v49
    v_add_f32 v44, v44, v45
    v_add_f32 v52, v52, v53
    v_permlane32_swap_b32 v40, v48
    v_lshl_add_u32 v122, v122, 1, v123
    v_permlane32_swap_b32 v44, v52
    v_add_f32 v40, v40, v48
    v_add_f32 v44, v44, v52
    v_cmp_eq_u32 vcc, 16, v1
    v_lshl_add_u32 v160, v122, 4, s76
    v_permlane16_swap_b32 v40, v44
    v_add_f32 v40, v40, v44
    v_mov_b32 v123, s76
    v_add_u32 v161, v160, v124
    v_add_f32_dpp v40, v40, v40 quad_perm:[1,0,3,2] row_mask:0xf bank_mask:0xf
    v_add_u32 v162, v161, v124
    v_add_u32 v163, v162, v124
    v_add_f32_dpp v40, v40, v40 quad_perm:[2,3,0,1] row_mask:0xf bank_mask:0xf
    v_cndmask_b32 v163, v163, v123, vcc
    s_mul_i32 s76, s36, 2304
    v_add_f32_dpp v40, v40, v40 row_half_mirror row_mask:0xf bank_mask:0xf
    v_lshrrev_b32 v122, 3, v1
    s_add_u32 s76, s76, 148480
    v_add_f32_dpp v40, v40, v40 row_mirror row_mask:0xf bank_mask:0xf
    v_mov_b32 v44, v40
    v_add_u32 v122, v122, v1
    v_lshl_add_u32 v59, v122, 4, s76
    v_permlane16_swap_b32 v40, v44
    v_mul_f32 v40, 0x3b000000, v40
    v_mul_f32 v44, 0x3b000000, v44
    v_fma_f32 v44, -v40, v40, v44
    v_max_f32 v44, 0, v44
    v_cvt_pk_bf16_f32 v44, 0, v44
    v_cvt_pk_bf16_f32 v40, 0, v40
    v_add_f32 v44, 0x3727c5ac, v44
    v_cvt_pk_bf16_f32 v44, 0, v44
    v_sqrt_f32 v44, v44
    v_readlane_b32 s80, v40, 0
    v_cvt_pk_bf16_f32 v44, 0, v44
    v_rcp_f32 v44, v44
    v_readlane_b32 s81, v40, 32
    v_readlane_b32 s82, v44, 0
    v_readlane_b32 s83, v44, 32
    v_pk_add_f32 v[72:73], v[72:73], s[80:81] op_sel_hi:[1,0] neg_lo:[0,1] neg_hi:[0,1]
    v_pk_add_f32 v[80:81], v[80:81], s[80:81] op_sel:[0,1] op_sel_hi:[1,1] neg_lo:[0,1] neg_hi:[0,1]
    v_pk_add_f32 v[74:75], v[74:75], s[80:81] op_sel_hi:[1,0] neg_lo:[0,1] neg_hi:[0,1]
    v_pk_add_f32 v[82:83], v[82:83], s[80:81] op_sel:[0,1] op_sel_hi:[1,1] neg_lo:[0,1] neg_hi:[0,1]
    v_pk_add_f32 v[76:77], v[76:77], s[80:81] op_sel_hi:[1,0] neg_lo:[0,1] neg_hi:[0,1]
    v_pk_add_f32 v[84:85], v[84:85], s[80:81] op_sel:[0,1] op_sel_hi:[1,1] neg_lo:[0,1] neg_hi:[0,1]
    v_pk_add_f32 v[78:79], v[78:79], s[80:81] op_sel_hi:[1,0] neg_lo:[0,1] neg_hi:[0,1]
    v_pk_add_f32 v[86:87], v[86:87], s[80:81] op_sel:[0,1] op_sel_hi:[1,1] neg_lo:[0,1] neg_hi:[0,1]
    v_cvt_pk_bf16_f32 v72, 0, v72
    v_cvt_pk_bf16_f32 v80, 0, v80
    v_cvt_pk_bf16_f32 v73, 0, v73
    v_cvt_pk_bf16_f32 v81, 0, v81
    v_cvt_pk_bf16_f32 v74, 0, v74
    v_cvt_pk_bf16_f32 v82, 0, v82
    v_cvt_pk_bf16_f32 v75, 0, v75
    v_cvt_pk_bf16_f32 v83, 0, v83
    v_cvt_pk_bf16_f32 v76, 0, v76
    v_cvt_pk_bf16_f32 v84, 0, v84
    v_cvt_pk_bf16_f32 v77, 0, v77
    v_cvt_pk_bf16_f32 v85, 0, v85
    v_cvt_pk_bf16_f32 v78, 0, v78
    v_cvt_pk_bf16_f32 v86, 0, v86
    v_cvt_pk_bf16_f32 v79, 0, v79
    v_cvt_pk_bf16_f32 v87, 0, v87
    v_pk_mul_f32 v[72:73], v[72:73], s[82:83] op_sel_hi:[1,0]
    v_pk_mul_f32 v[80:81], v[80:81], s[82:83] op_sel:[0,1] op_sel_hi:[1,1]
    v_pk_mul_f32 v[74:75], v[74:75], s[82:83] op_sel_hi:[1,0]
    v_pk_mul_f32 v[82:83], v[82:83], s[82:83] op_sel:[0,1] op_sel_hi:[1,1]
    v_pk_mul_f32 v[76:77], v[76:77], s[82:83] op_sel_hi:[1,0]
    v_pk_mul_f32 v[84:85], v[84:85], s[82:83] op_sel:[0,1] op_sel_hi:[1,1]
    v_pk_mul_f32 v[78:79], v[78:79], s[82:83] op_sel_hi:[1,0]
    v_pk_mul_f32 v[86:87], v[86:87], s[82:83] op_sel:[0,1] op_sel_hi:[1,1]
    v_cvt_pk_bf16_f32 v88, v72, v73
    v_cvt_pk_bf16_f32 v92, v80, v81
    v_cvt_pk_bf16_f32 v89, v74, v75
    v_cvt_pk_bf16_f32 v93, v82, v83
    v_cvt_pk_bf16_f32 v90, v76, v77
    v_cvt_pk_bf16_f32 v94, v84, v85
    v_cvt_pk_bf16_f32 v91, v78, v79
    v_cvt_pk_bf16_f32 v95, v86, v87
    ds_write_b128 v56, v[88:91] offset:8704
    ds_write_b128 v56, v[92:95] offset:9792
    v_lshrrev_b32 v122, 2, v1
    v_and_b32 v123, 3, v1
    v_lshlrev_b32 v123, 4, v123
    v_lshl_add_u32 v60, v122, 14, v123
    v_bfe_u32 v120, v1, 2, 2
    v_lshrrev_b32 v121, 4, v1
    v_lshlrev_b32 v121, 10, v121
    v_lshl_add_u32 v121, v120, 7, v121
    s_waitcnt lgkmcnt(0)
    s_barrier
    ds_read_b64_tr_b16 v[64:65], v57 offset:0
    ds_read_b64_tr_b16 v[66:67], v57 offset:4352
    ds_read_b64_tr_b16 v[68:69], v57 offset:128
    ds_read_b64_tr_b16 v[70:71], v57 offset:4480
    ds_read_b64_tr_b16 v[72:73], v61 offset:0
    ds_read_b64_tr_b16 v[74:75], v61 offset:512
    ds_read_b64_tr_b16 v[76:77], v61 offset:1088
    ds_read_b64_tr_b16 v[78:79], v61 offset:1600
    v_and_b32 v122, 3, v1
    v_and_b32 v123, 24, v1
    v_lshlrev_b32 v123, 2, v123
    v_lshl_or_b32 v122, v122, 3, v123
    v_xor_b32 v122, s79, v122
    v_add3_u32 v12, v121, v122, s42
    v_xor_b32 v13, 32, v12
    v_xor_b32 v14, 64, v12
    v_xor_b32 v15, 96, v12
    s_waitcnt lgkmcnt(6)
    buffer_store_dwordx4 v[64:67], v58, s[16:19], s60 offen sc1
    s_waitcnt lgkmcnt(4)
    buffer_store_dwordx4 v[68:71], v58, s[16:19], s61 offen sc1
    s_cmp_eq_u32 s41, 7
    s_cbranch_scc1 L_fft
    s_waitcnt lgkmcnt(2)
    v_mfma_f32_16x16x32_bf16 v[80:83], v[72:75], v[128:131], 0
    v_mfma_f32_16x16x32_bf16 v[88:91], v[72:75], v[132:135], 0
    s_waitcnt lgkmcnt(0)
    v_mfma_f32_16x16x32_bf16 v[84:87], v[76:79], v[128:131], 0
    v_mfma_f32_16x16x32_bf16 v[92:95], v[76:79], v[132:135], 0
    s_nop 3
    v_pk_mul_f32 v[96:97], v[80:81], v[136:137]
    v_pk_mul_f32 v[104:105], v[88:89], v[136:137]
    v_pk_mul_f32 v[98:99], v[82:83], v[138:139]
    v_pk_mul_f32 v[106:107], v[90:91], v[138:139]
    v_pk_fma_f32 v[96:97], v[88:89], v[140:141], v[96:97]
    v_pk_fma_f32 v[104:105], v[80:81], v[140:141], v[104:105] neg_lo:[1,0,0] neg_hi:[1,0,0]
    s_add_u32 m0, s42, 8192
    s_mul_i32 s46, s48, s50
    buffer_load_dwordx4 v4, s[8:11], s46 offen offset:0 lds
    s_add_u32 s48, s48, 1
    s_cmp_eq_u32 s48, s49
    s_cselect_b32 s48, 0, s48
    v_pk_fma_f32 v[98:99], v[90:91], v[142:143], v[98:99]
    v_pk_fma_f32 v[106:107], v[82:83], v[142:143], v[106:107] neg_lo:[1,0,0] neg_hi:[1,0,0]
    v_cvt_pk_bf16_f32 v112, v96, v97
    v_cvt_pk_bf16_f32 v114, v104, v105
    v_cvt_pk_bf16_f32 v113, v98, v99
    v_cvt_pk_bf16_f32 v115, v106, v107
    v_pk_mul_f32 v[100:101], v[84:85], v[136:137]
    v_pk_mul_f32 v[108:109], v[92:93], v[136:137]
    v_pk_mul_f32 v[102:103], v[86:87], v[138:139]
    v_pk_mul_f32 v[110:111], v[94:95], v[138:139]
    buffer_load_dwordx4 v5, s[8:11], s46 offen offset:1024 lds
    v_pk_fma_f32 v[100:101], v[92:93], v[140:141], v[100:101]
    v_pk_fma_f32 v[108:109], v[84:85], v[140:141], v[108:109] neg_lo:[1,0,0] neg_hi:[1,0,0]
    v_pk_fma_f32 v[102:103], v[94:95], v[142:143], v[102:103]
    v_pk_fma_f32 v[110:111], v[86:87], v[142:143], v[110:111] neg_lo:[1,0,0] neg_hi:[1,0,0]
    v_cvt_pk_bf16_f32 v116, v100, v101
    v_cvt_pk_bf16_f32 v118, v108, v109
    v_cvt_pk_bf16_f32 v117, v102, v103
    v_cvt_pk_bf16_f32 v119, v110, v111
    v_mfma_f32_16x16x32_bf16 v[164:167], v[144:147], v[112:115], 0
    v_mfma_f32_16x16x32_bf16 v[180:183], v[152:155], v[112:115], 0
    buffer_load_dwordx4 v6, s[8:11], s46 offen offset:2048 lds
    v_mfma_f32_16x16x32_bf16 v[172:175], v[148:151], v[112:115], 0
    v_mfma_f32_16x16x32_bf16 v[188:191], v[156:159], v[112:115], 0
    v_mfma_f32_16x16x32_bf16 v[168:171], v[144:147], v[116:119], 0
    v_mfma_f32_16x16x32_bf16 v[184:187], v[152:155], v[116:119], 0
    v_mfma_f32_16x16x32_bf16 v[176:179], v[148:151], v[116:119], 0
    v_mfma_f32_16x16x32_bf16 v[192:195], v[156:159], v[116:119], 0
    s_nop 0
    v_cndmask_b32 v164, v164, v180, s[90:91]
    v_cndmask_b32 v165, v165, v181, s[90:91]
    v_cndmask_b32 v166, v166, v182, s[90:91]
    v_cndmask_b32 v167, v167, v183, s[90:91]
    buffer_load_dwordx4 v7, s[8:11], s46 offen offset:3072 lds
    v_cndmask_b32 v168, v168, v184, s[90:91]
    v_cndmask_b32 v169, v169, v185, s[90:91]
    v_cndmask_b32 v170, v170, v186, s[90:91]
    v_cndmask_b32 v171, v171, v187, s[90:91]
    v_cndmask_b32 v172, v172, v188, s[90:91]
    v_cndmask_b32 v173, v173, v189, s[90:91]
    v_cndmask_b32 v174, v174, v190, s[90:91]
    v_cndmask_b32 v175, v175, v191, s[90:91]
    v_cndmask_b32 v176, v176, v192, s[90:91]
    v_cndmask_b32 v177, v177, v193, s[90:91]
    s_add_u32 m0, s42, 12288
    s_add_u32 s46, s46, s51
    buffer_load_dwordx4 v4, s[8:11], s46 offen offset:0 lds
    v_cndmask_b32 v178, v178, v194, s[90:91]
    v_cndmask_b32 v179, v179, v195, s[90:91]
    v_cvt_pk_bf16_f32 v80, v164, v168
    v_cvt_pk_bf16_f32 v81, v172, v176
    ds_write_b64 v160, v[80:81]
    v_cvt_pk_bf16_f32 v82, v165, v169
    v_cvt_pk_bf16_f32 v83, v173, v177
    ds_write_b64 v161, v[82:83]
    v_cvt_pk_bf16_f32 v84, v166, v170
    v_cvt_pk_bf16_f32 v85, v174, v178
    buffer_load_dwordx4 v5, s[8:11], s46 offen offset:1024 lds
    ds_write_b64 v162, v[84:85]
    v_cvt_pk_bf16_f32 v86, v167, v171
    v_cvt_pk_bf16_f32 v87, v175, v179
    ds_write_b64 v163, v[86:87]
    s_waitcnt vmcnt(6)
    s_atomic_swap s37, s[16:17], s56
    ds_read_b32 v39, v3
    s_waitcnt lgkmcnt(1)
    s_barrier
    ds_read_b128 v[64:67], v59
    ds_read_b128 v[68:71], v59 offset:1152
    s_waitcnt lgkmcnt(1)
    buffer_store_dwordx4 v[64:67], v60, s[16:19], s62 offen sc1
    ds_read_b32 v39, v3
    s_waitcnt lgkmcnt(1)
    buffer_store_dwordx4 v[68:71], v60, s[16:19], s63 offen sc1
    buffer_load_dwordx4 v6, s[8:11], s46 offen offset:2048 lds
    v_lshrrev_b32 v42, 3, v1
    v_and_b32 v43, 7, v1
    v_and_b32 v44, 2, v42
    v_xor_b32 v43, v43, v44
    s_mul_i32 s76, s36, 1835008
    s_lshl_b32 s78, s40, 7
    v_and_b32 v44, 4, v42
    v_mad_u32_u24 v44, v44, 3, v42
    v_lshlrev_b32 v44, 12, v44
    s_mov_b32 s52, s64
    buffer_load_dwordx4 v7, s[8:11], s46 offen offset:3072 lds
    s_add_u32 s76, s76, s78
    v_lshl_add_u32 v44, v43, 4, v44
    v_add_u32 v8, s76, v44
    s_mov_b32 s53, 7
    s_add_u32 m0, s42, 16384
    s_mul_i32 s46, s48, s50
    buffer_load_dwordx4 v4, s[8:11], s46 offen offset:0 lds
    s_add_u32 s48, s48, 1
    s_cmp_eq_u32 s48, s49
    s_cselect_b32 s48, 0, s48
    s_mov_b32 s54, 262144
    ds_read_b64_tr_b16 a[0:1], v12 offset:0
    s_mov_b32 s55, 131072
    ds_read_b64_tr_b16 a[2:3], v12 offset:512
    v_xor_b32 v44, 64, v8
    v_add_u32 v9, 15360, v44
    v_add_u32 v10, 30720, v8
    v_add_u32 v11, 46080, v44
    buffer_load_dwordx4 v5, s[8:11], s46 offen offset:1024 lds
    s_lshl_b32 s79, s36, 5
    ds_read_b64_tr_b16 a[4:5], v13 offset:0
    v_bfe_u32 v42, v1, 2, 2
    ds_read_b64_tr_b16 a[6:7], v13 offset:512
    v_lshrrev_b32 v43, 4, v1
    v_lshlrev_b32 v43, 10, v43
    v_lshl_add_u32 v43, v42, 7, v43
    v_and_b32 v44, 3, v1
    buffer_load_dwordx4 v6, s[8:11], s46 offen offset:2048 lds
    v_and_b32 v45, 24, v1
    ds_read_b64_tr_b16 a[8:9], v14 offset:0
    v_lshlrev_b32 v45, 2, v45
    ds_read_b64_tr_b16 a[10:11], v14 offset:512
    v_lshl_or_b32 v44, v44, 3, v45
    v_xor_b32 v44, s79, v44
    v_add3_u32 v244, v43, v44, s42
    v_xor_b32 v245, 32, v244
    buffer_load_dwordx4 v7, s[8:11], s46 offen offset:3072 lds
    v_xor_b32 v246, 64, v244
    ds_read_b64_tr_b16 a[12:13], v15 offset:0
    v_xor_b32 v247, 96, v244
    ds_read_b64_tr_b16 a[14:15], v15 offset:512
    s_barrier
    v_lshlrev_b32 v40, 4, v1
    s_mul_i32 s76, s38, 262144
    s_mul_i32 s77, s36, 32768
    s_add_u32 m0, s42, 20480
    s_add_u32 s46, s46, s51
    buffer_load_dwordx4 v4, s[8:11], s46 offen offset:0 lds
    s_add_u32 s76, s76, s77
    ds_read_b64_tr_b16 a[16:17], v12 offset:4096
    s_add_u32 s76, s76, 2199552
    ds_read_b64_tr_b16 a[18:19], v12 offset:4608
    s_and_b32 s77, s36, 1
    s_lshl_b32 s77, s77, 10
    s_add_u32 s78, s76, s77
    s_sub_u32 s76, s76, s77
    buffer_load_dwordx4 v5, s[8:11], s46 offen offset:1024 lds
    v_add_u32 v16, s78, v40
    ds_read_b64_tr_b16 a[20:21], v13 offset:4096
    v_add_u32 v17, s76, v40
    ds_read_b64_tr_b16 a[22:23], v13 offset:4608
    v_add_u32 v18, 131072, v16
    v_add_u32 v19, 131072, v17
    s_mul_i32 s76, s38, 229376
    s_lshl2_add_u32 s77, s39, s36
    buffer_load_dwordx4 v6, s[8:11], s46 offen offset:2048 lds
    s_lshl_b32 s77, s77, 10
    ds_read_b64_tr_b16 a[24:25], v14 offset:4096
    s_add_u32 s76, s76, s77
    ds_read_b64_tr_b16 a[26:27], v14 offset:4608
    s_add_u32 s76, s76, 6590464
    v_add_u32 v35, s76, v40
    s_mul_i32 s76, s41, 229376
    s_mul_i32 s77, s36, 28672
    buffer_load_dwordx4 v7, s[8:11], s46 offen offset:3072 lds
    s_add_u32 s76, s76, s77
    ds_read_b64_tr_b16 a[28:29], v15 offset:4096
    s_add_u32 s76, s76, 6590464
    ds_read_b64_tr_b16 a[30:31], v15 offset:4608
    v_add_u32 v56, s76, v40
    v_add_u32 v57, 114688, v56
    s_xor_b32 s76, s36, 1
    s_mul_i32 s76, s76, 6144
    s_add_u32 m0, s42, 24576
    s_mul_i32 s46, s48, s50
    buffer_load_dwordx4 v4, s[8:11], s46 offen offset:0 lds
    s_add_u32 s48, s48, 1
    s_cmp_eq_u32 s48, s49
    s_cselect_b32 s48, 0, s48
    s_add_u32 s76, s76, 131072
    s_waitcnt vmcnt(15)
    ds_read_b64_tr_b16 a[32:33], v12 offset:8192
    v_add_u32 v20, s76, v40
    ds_read_b64_tr_b16 a[34:35], v12 offset:8704
    s_xor_b32 s76, s36, 2
    s_mul_i32 s76, s76, 6144
    s_add_u32 s76, s76, 133120
    v_add_u32 v21, s76, v40
    buffer_load_dwordx4 v5, s[8:11], s46 offen offset:1024 lds
    s_xor_b32 s76, s36, 3
    ds_read_b64_tr_b16 a[36:37], v13 offset:8192
    s_mul_i32 s76, s76, 6144
    ds_read_b64_tr_b16 a[38:39], v13 offset:8704
    s_add_u32 s76, s76, 135168
    v_add_u32 v22, s76, v40
    s_mul_i32 s76, s36, 6144
    s_add_u32 s76, s76, 131072
    buffer_load_dwordx4 v6, s[8:11], s46 offen offset:2048 lds
    v_add_u32 v23, s76, v40
    ds_read_b64_tr_b16 a[40:41], v14 offset:8192
    v_lshrrev_b32 v41, 10, v36
    ds_read_b64_tr_b16 a[42:43], v14 offset:8704
    v_bfe_u32 v42, v36, 1, 9
    s_and_b32 s76, s41, 3
    s_cmp_lg_u32 s76, 0
    s_cselect_b64 s[90:91], 0, 0xffff
    s_cmp_eq_u32 s41, 0
    s_cselect_b32 s3, 0, 16
    s_cselect_b32 s89, 1060864, 0
    s_add_u32 s89, s89, 8785920
    s_cmp_ge_u32 s41, 4
    s_cselect_b32 s88, 0xffff, -1
    s_cselect_b64 s[92:93], -1, 0
    s_cselect_b32 s76, 3, 0
    s_xor_b32 s84, s76, 0
    buffer_load_dwordx4 v7, s[8:11], s46 offen offset:3072 lds
    s_lshl_b32 s84, s84, 13
    ds_read_b64_tr_b16 a[44:45], v15 offset:8192
    s_xor_b32 s85, s76, 1
    ds_read_b64_tr_b16 a[46:47], v15 offset:8704
    s_lshl_b32 s85, s85, 13
    s_waitcnt vmcnt(14)
    s_atomic_swap s37, s[16:17], s57
    s_xor_b32 s86, s76, 2
    s_lshl_b32 s86, s86, 13
    s_xor_b32 s87, s76, 3
    s_lshl_b32 s87, s87, 13
    s_add_u32 m0, s42, 28672
    s_add_u32 s46, s46, s51
    buffer_load_dwordx4 v4, s[8:11], s46 offen offset:0 lds
    v_sub_u32 v43, 2048, v41
    s_waitcnt vmcnt(13)
    ds_read_b64_tr_b16 a[48:49], v12 offset:12288
    v_and_b32 v43, 2047, v43
    ds_read_b64_tr_b16 a[50:51], v12 offset:12800
    v_cndmask_b32 v43, v41, v43, s[92:93]
    v_lshlrev_b32 v44, 2, v43
    v_add_u32 v44, 8785920, v44
    v_lshrrev_b32 v41, 1, v42
    buffer_load_dwordx4 v5, s[8:11], s46 offen offset:1024 lds
    v_add_u32 v41, 0, v41
    ds_read_b64_tr_b16 a[52:53], v13 offset:12288
    v_sub_u32 v43, 256, v41
    ds_read_b64_tr_b16 a[54:55], v13 offset:12800
    v_and_b32 v45, 127, v43
    v_cndmask_b32 v45, v41, v45, s[92:93]
    v_lshl_add_u32 v58, v45, 13, v44
    v_add_u32 v41, 1, v41
    buffer_load_dwordx4 v6, s[8:11], s46 offen offset:2048 lds
    v_subrev_u32 v43, 4, v43
    ds_read_b64_tr_b16 a[56:57], v14 offset:12288
    v_cndmask_b32 v45, v41, v43, s[92:93]
    ds_read_b64_tr_b16 a[58:59], v14 offset:12800
    v_lshl_add_u32 v60, v45, 13, v44
    v_lshrrev_b32 v41, 1, v42
    v_add_u32 v41, 16, v41
    v_sub_u32 v43, 256, v41
    buffer_load_dwordx4 v7, s[8:11], s46 offen offset:3072 lds
    v_and_b32 v45, 127, v43
    ds_read_b64_tr_b16 a[60:61], v15 offset:12288
    v_cndmask_b32 v45, v41, v45, s[92:93]
    ds_read_b64_tr_b16 a[62:63], v15 offset:12800
    v_lshl_add_u32 v59, v45, 13, v44
    v_add_u32 v41, 1, v41
    v_subrev_u32 v43, 4, v43
    v_cndmask_b32 v45, v41, v43, s[92:93]
    s_waitcnt lgkmcnt(15)
    s_add_u32 m0, s42, 0
    s_mul_i32 s46, s48, s50
    buffer_load_dwordx4 v4, s[8:11], s46 offen offset:0 lds
    s_add_u32 s48, s48, 1
    s_cmp_eq_u32 s48, s49
    s_cselect_b32 s48, 0, s48
    v_lshl_add_u32 v61, v45, 13, v44
    s_waitcnt vmcnt(13)
    ds_read_b64_tr_b16 a[64:65], v12 offset:16384
    s_lshl_b32 s76, s41, 3
    ds_read_b64_tr_b16 a[66:67], v12 offset:16896
    v_min_u32 v41, 7, v1
    v_add_u32 v41, s76, v41
    s_sub_u32 s76, 64, s76
    v_min_u32 v43, 8, v1
    buffer_load_dwordx4 v5, s[8:11], s46 offen offset:1024 lds
    v_sub_u32 v43, s76, v43
    ds_read_b64_tr_b16 a[68:69], v13 offset:16384
    v_and_b32 v43, 31, v43
    ds_read_b64_tr_b16 a[70:71], v13 offset:16896
    v_cndmask_b32 v41, v41, v43, s[92:93]
    v_lshlrev_b32 v41, 3, v41
    v_add_u32 v62, 557056, v41
    s_bfe_u32 s76, s2, 0x20001
    buffer_load_dwordx4 v6, s[8:11], s46 offen offset:2048 lds
    s_lshl2_add_u32 s76, s38, s76
    ds_read_b64_tr_b16 a[72:73], v14 offset:16384
    s_lshl_b32 s76, s76, 7
    ds_read_b64_tr_b16 a[74:75], v14 offset:16896
    s_add_u32 s58, s76, 327680
    s_and_b32 s76, s2, 3
    s_lshl3_add_u32 s76, s76, s41
    s_lshl2_add_u32 s76, s76, s36
    buffer_load_dwordx4 v7, s[8:11], s46 offen offset:3072 lds
    s_lshl_b32 s76, s76, 7
    ds_read_b64_tr_b16 a[76:77], v15 offset:16384
    s_add_u32 s59, s76, 327680
    ds_read_b64_tr_b16 a[78:79], v15 offset:16896
    s_add_u32 s65, s37, 28
    s_mov_b32 s95, 1
    v_lshlrev_b32 v24, 16, v28
    v_and_b32 v25, 0xffff0000, v28
    s_add_u32 m0, s42, 4096
    s_add_u32 s46, s46, s51
    buffer_load_dwordx4 v4, s[8:11], s46 offen offset:0 lds
    v_lshlrev_b32 v26, 16, v29
    s_waitcnt vmcnt(13)
    ds_read_b64_tr_b16 a[80:81], v12 offset:20480
    v_and_b32 v27, 0xffff0000, v29
    ds_read_b64_tr_b16 a[82:83], v12 offset:20992
    v_lshlrev_b32 v28, 16, v30
    v_and_b32 v29, 0xffff0000, v30
    v_lshlrev_b32 v30, 16, v31
    v_and_b32 v31, 0xffff0000, v31
    buffer_load_dwordx4 v5, s[8:11], s46 offen offset:1024 lds
    s_lshr_b32 s76, s38, 1
    ds_read_b64_tr_b16 a[84:85], v13 offset:20480
    s_lshl2_add_u32 s76, s76, s36
    ds_read_b64_tr_b16 a[86:87], v13 offset:20992
    s_lshl_b32 s76, s76, 10
    s_add_u32 s76, s76, 65536
    v_lshlrev_b32 v32, 4, v1
    s_lshl_b32 s45, s44, 12
    buffer_load_dwordx4 v6, s[8:11], s46 offen offset:2048 lds
    ds_read_b64_tr_b16 a[88:89], v14 offset:20480
    ds_read_b64_tr_b16 a[90:91], v14 offset:20992
    buffer_load_dwordx4 v7, s[8:11], s46 offen offset:3072 lds
    ds_read_b64_tr_b16 a[92:93], v15 offset:20480
    ds_read_b64_tr_b16 a[94:95], v15 offset:20992
    s_waitcnt lgkmcnt(15)
    s_add_u32 m0, s42, 8192
    s_mul_i32 s46, s48, s50
    buffer_load_dwordx4 v4, s[8:11], s46 offen offset:0 lds
    s_add_u32 s48, s48, 1
    s_cmp_eq_u32 s48, s49
    s_cselect_b32 s48, 0, s48
    s_waitcnt vmcnt(13)
    ds_read_b64_tr_b16 a[96:97], v12 offset:24576
    ds_read_b64_tr_b16 a[98:99], v12 offset:25088
    buffer_load_dwordx4 v5, s[8:11], s46 offen offset:1024 lds
    ds_read_b64_tr_b16 a[100:101], v13 offset:24576
    ds_read_b64_tr_b16 a[102:103], v13 offset:25088
    buffer_load_dwordx4 v6, s[8:11], s46 offen offset:2048 lds
    ds_read_b64_tr_b16 a[104:105], v14 offset:24576
    ds_read_b64_tr_b16 a[106:107], v14 offset:25088
    buffer_load_dwordx4 v7, s[8:11], s46 offen offset:3072 lds
    ds_read_b64_tr_b16 a[108:109], v15 offset:24576
    ds_read_b64_tr_b16 a[110:111], v15 offset:25088
    s_add_u32 m0, s42, 12288
    s_add_u32 s46, s46, s51
    buffer_load_dwordx4 v4, s[8:11], s46 offen offset:0 lds
    s_waitcnt vmcnt(13)
    ds_read_b64_tr_b16 a[112:113], v12 offset:28672
    ds_read_b64_tr_b16 a[114:115], v12 offset:29184
    buffer_load_dwordx4 v5, s[8:11], s46 offen offset:1024 lds
    ds_read_b64_tr_b16 a[116:117], v13 offset:28672
    ds_read_b64_tr_b16 a[118:119], v13 offset:29184
    buffer_load_dwordx4 v6, s[8:11], s46 offen offset:2048 lds
    ds_read_b64_tr_b16 a[120:121], v14 offset:28672
    ds_read_b64_tr_b16 a[122:123], v14 offset:29184
    buffer_load_dwordx4 v7, s[8:11], s46 offen offset:3072 lds
    ds_read_b64_tr_b16 a[124:125], v15 offset:28672
    ds_read_b64_tr_b16 a[126:127], v15 offset:29184
    s_waitcnt lgkmcnt(15)
    s_add_u32 m0, s42, 16384
    s_mul_i32 s46, s48, s50
    buffer_load_dwordx4 v4, s[8:11], s46 offen offset:0 lds
    s_add_u32 s48, s48, 1
    s_cmp_eq_u32 s48, s49
    s_cselect_b32 s48, 0, s48
    s_waitcnt vmcnt(13)
    ds_read_b64_tr_b16 a[128:129], v12 offset:0
    ds_read_b64_tr_b16 a[130:131], v12 offset:512
    buffer_load_dwordx4 v5, s[8:11], s46 offen offset:1024 lds
    ds_read_b64_tr_b16 a[132:133], v13 offset:0
    ds_read_b64_tr_b16 a[134:135], v13 offset:512
    buffer_load_dwordx4 v6, s[8:11], s46 offen offset:2048 lds
    ds_read_b64_tr_b16 a[136:137], v14 offset:0
    ds_read_b64_tr_b16 a[138:139], v14 offset:512
    buffer_load_dwordx4 v7, s[8:11], s46 offen offset:3072 lds
    ds_read_b64_tr_b16 a[140:141], v15 offset:0
    ds_read_b64_tr_b16 a[142:143], v15 offset:512
    s_add_u32 m0, s42, 20480
    s_add_u32 s46, s46, s51
    buffer_load_dwordx4 v4, s[8:11], s46 offen offset:0 lds
    s_waitcnt vmcnt(13)
    ds_read_b64_tr_b16 a[144:145], v12 offset:4096
    ds_read_b64_tr_b16 a[146:147], v12 offset:4608
    buffer_load_dwordx4 v5, s[8:11], s46 offen offset:1024 lds
    ds_read_b64_tr_b16 a[148:149], v13 offset:4096
    ds_read_b64_tr_b16 a[150:151], v13 offset:4608
    buffer_load_dwordx4 v6, s[8:11], s46 offen offset:2048 lds
    ds_read_b64_tr_b16 a[152:153], v14 offset:4096
    ds_read_b64_tr_b16 a[154:155], v14 offset:4608
    buffer_load_dwordx4 v7, s[8:11], s46 offen offset:3072 lds
    buffer_load_dword v33, v32, s[16:19], s76 offen sc1
    ds_read_b64_tr_b16 a[156:157], v15 offset:4096
    ds_read_b64_tr_b16 a[158:159], v15 offset:4608
    s_waitcnt lgkmcnt(15)
    s_add_u32 m0, s42, 24576
    s_mul_i32 s46, s48, s50
    buffer_load_dwordx4 v4, s[8:11], s46 offen offset:0 lds
    s_add_u32 s48, s48, 1
    s_cmp_eq_u32 s48, s49
    s_cselect_b32 s48, 0, s48
    s_waitcnt vmcnt(14)
    ds_read_b64_tr_b16 a[160:161], v12 offset:8192
    ds_read_b64_tr_b16 a[162:163], v12 offset:8704
    buffer_load_dwordx4 v5, s[8:11], s46 offen offset:1024 lds
    ds_read_b64_tr_b16 a[164:165], v13 offset:8192
    ds_read_b64_tr_b16 a[166:167], v13 offset:8704
    buffer_load_dwordx4 v6, s[8:11], s46 offen offset:2048 lds
    ds_read_b64_tr_b16 a[168:169], v14 offset:8192
    ds_read_b64_tr_b16 a[170:171], v14 offset:8704
    buffer_load_dwordx4 v7, s[8:11], s46 offen offset:3072 lds
    ds_read_b64_tr_b16 a[172:173], v15 offset:8192
    ds_read_b64_tr_b16 a[174:175], v15 offset:8704
    s_add_u32 m0, s42, 28672
    s_add_u32 s46, s46, s51
    buffer_load_dwordx4 v4, s[8:11], s46 offen offset:0 lds
    s_waitcnt vmcnt(14)
    ds_read_b64_tr_b16 a[176:177], v12 offset:12288
    ds_read_b64_tr_b16 a[178:179], v12 offset:12800
    buffer_load_dwordx4 v5, s[8:11], s46 offen offset:1024 lds
    ds_read_b64_tr_b16 a[180:181], v13 offset:12288
    ds_read_b64_tr_b16 a[182:183], v13 offset:12800
    buffer_load_dwordx4 v6, s[8:11], s46 offen offset:2048 lds
    ds_read_b64_tr_b16 a[184:185], v14 offset:12288
    ds_read_b64_tr_b16 a[186:187], v14 offset:12800
    buffer_load_dwordx4 v7, s[8:11], s46 offen offset:3072 lds
    ds_read_b64_tr_b16 a[188:189], v15 offset:12288
    ds_read_b64_tr_b16 a[190:191], v15 offset:12800
    s_waitcnt vmcnt(13)
    ds_read_b64_tr_b16 a[192:193], v12 offset:16384
    ds_read_b64_tr_b16 a[194:195], v12 offset:16896
    ds_read_b64_tr_b16 a[196:197], v13 offset:16384
    ds_read_b64_tr_b16 a[198:199], v13 offset:16896
    ds_read_b64_tr_b16 a[200:201], v14 offset:16384
    ds_read_b64_tr_b16 a[202:203], v14 offset:16896
    ds_read_b64_tr_b16 a[204:205], v15 offset:16384
    ds_read_b64_tr_b16 a[206:207], v15 offset:16896
    s_waitcnt vmcnt(8)
    v_cmp_ne_u32 vcc, v33, v2
    s_cbranch_vccz L_fast_2
    s_mov_b32 s43, 200000
L_poll_3:
    buffer_load_dword v33, v32, s[16:19], s76 offen sc1
    s_waitcnt vmcnt(0)
    v_cmp_ne_u32 vcc, v33, v2
    s_cbranch_vccz L_polled_4
    s_sub_u32 s43, s43, 1
    s_cbranch_scc0 L_poll_3
L_polled_4:
L_fast_2:
    buffer_load_dwordx4 v[128:131], v16, s[16:19], s45 offen offset:0 sc1
    buffer_load_dwordx4 v[132:135], v17, s[16:19], s45 offen offset:1024 sc1
    buffer_load_dwordx4 v[136:139], v16, s[16:19], s45 offen offset:2048 sc1
    buffer_load_dwordx4 v[140:143], v17, s[16:19], s45 offen offset:3072 sc1
    s_add_u32 s45, s45, 4096
    s_and_b32 s45, s45, 0x7fff
    buffer_load_dwordx4 v[144:147], v16, s[16:19], s45 offen offset:0 sc1
    buffer_load_dwordx4 v[148:151], v17, s[16:19], s45 offen offset:1024 sc1
    buffer_load_dwordx4 v[152:155], v16, s[16:19], s45 offen offset:2048 sc1
    ds_read_b64_tr_b16 a[208:209], v12 offset:20480
    ds_read_b64_tr_b16 a[210:211], v12 offset:20992
    ds_read_b64_tr_b16 a[212:213], v13 offset:20480
    buffer_load_dwordx4 v[156:159], v17, s[16:19], s45 offen offset:3072 sc1
    s_add_u32 s45, s45, 4096
    s_and_b32 s45, s45, 0x7fff
    ds_read_b64_tr_b16 a[214:215], v13 offset:20992
    ds_read_b64_tr_b16 a[216:217], v14 offset:20480
    ds_read_b64_tr_b16 a[218:219], v14 offset:20992
    buffer_load_dwordx4 v[160:163], v16, s[16:19], s45 offen offset:0 sc1
    ds_read_b64_tr_b16 a[220:221], v15 offset:20480
    ds_read_b64_tr_b16 a[222:223], v15 offset:20992
    s_waitcnt vmcnt(13)
    ds_read_b64_tr_b16 a[224:225], v12 offset:24576
    buffer_load_dwordx4 v[164:167], v17, s[16:19], s45 offen offset:1024 sc1
    ds_read_b64_tr_b16 a[226:227], v12 offset:25088
    ds_read_b64_tr_b16 a[228:229], v13 offset:24576
    ds_read_b64_tr_b16 a[230:231], v13 offset:25088
    buffer_load_dwordx4 v[168:171], v16, s[16:19], s45 offen offset:2048 sc1
    ds_read_b64_tr_b16 a[232:233], v14 offset:24576
    ds_read_b64_tr_b16 a[234:235], v14 offset:25088
    ds_read_b64_tr_b16 a[236:237], v15 offset:24576
    buffer_load_dwordx4 v[172:175], v17, s[16:19], s45 offen offset:3072 sc1
    s_add_u32 s45, s45, 4096
    s_and_b32 s45, s45, 0x7fff
    ds_read_b64_tr_b16 a[238:239], v15 offset:25088
    s_waitcnt vmcnt(12)
    ds_read_b64_tr_b16 a[240:241], v12 offset:28672
    ds_read_b64_tr_b16 a[242:243], v12 offset:29184
    buffer_load_dwordx4 v[176:179], v16, s[16:19], s45 offen offset:0 sc1
    ds_read_b64_tr_b16 a[244:245], v13 offset:28672
    ds_read_b64_tr_b16 a[246:247], v13 offset:29184
    ds_read_b64_tr_b16 a[248:249], v14 offset:28672
    buffer_load_dwordx4 v[180:183], v17, s[16:19], s45 offen offset:1024 sc1
    ds_read_b64_tr_b16 a[250:251], v14 offset:29184
    ds_read_b64_tr_b16 a[252:253], v15 offset:28672
    ds_read_b64_tr_b16 a[254:255], v15 offset:29184
    s_waitcnt vmcnt(13)
    v_mfma_f32_16x16x32_bf16 v[64:67], a[0:3], v[128:131], 0
    v_mfma_f32_16x16x32_bf16 v[68:71], a[4:7], v[128:131], 0
    s_waitcnt vmcnt(12)
    v_mfma_f32_16x16x32_bf16 v[72:75], a[0:3], v[132:135], 0
    v_mfma_f32_16x16x32_bf16 v[76:79], a[4:7], v[132:135], 0
    v_mfma_f32_16x16x32_bf16 v[80:83], a[8:11], v[128:131], 0
    v_mfma_f32_16x16x32_bf16 v[84:87], a[12:15], v[128:131], 0
    v_mfma_f32_16x16x32_bf16 v[88:91], a[8:11], v[132:135], 0
    v_mfma_f32_16x16x32_bf16 v[92:95], a[12:15], v[132:135], 0
    s_waitcnt vmcnt(11)
    v_mfma_f32_16x16x32_bf16 v[64:67], a[16:19], v[136:139], v[64:67]
    buffer_load_dwordx4 v[128:131], v16, s[16:19], s45 offen offset:2048 sc1
    v_mfma_f32_16x16x32_bf16 v[68:71], a[20:23], v[136:139], v[68:71]
    s_waitcnt vmcnt(11)
    v_mfma_f32_16x16x32_bf16 v[72:75], a[16:19], v[140:143], v[72:75]
    v_mfma_f32_16x16x32_bf16 v[76:79], a[20:23], v[140:143], v[76:79]
    v_mfma_f32_16x16x32_bf16 v[80:83], a[24:27], v[136:139], v[80:83]
    buffer_load_dwordx4 v[132:135], v17, s[16:19], s45 offen offset:3072 sc1
    s_add_u32 s45, s45, 4096
    s_and_b32 s45, s45, 0x7fff
    v_mfma_f32_16x16x32_bf16 v[84:87], a[28:31], v[136:139], v[84:87]
    v_mfma_f32_16x16x32_bf16 v[88:91], a[24:27], v[140:143], v[88:91]
    v_mfma_f32_16x16x32_bf16 v[92:95], a[28:31], v[140:143], v[92:95]
    s_waitcnt vmcnt(11)
    v_mfma_f32_16x16x32_bf16 v[64:67], a[32:35], v[144:147], v[64:67]
    buffer_load_dwordx4 v[136:139], v16, s[16:19], s45 offen offset:0 sc1
    v_mfma_f32_16x16x32_bf16 v[68:71], a[36:39], v[144:147], v[68:71]
    s_waitcnt vmcnt(11)
    v_mfma_f32_16x16x32_bf16 v[72:75], a[32:35], v[148:151], v[72:75]
    v_mfma_f32_16x16x32_bf16 v[76:79], a[36:39], v[148:151], v[76:79]
    v_mfma_f32_16x16x32_bf16 v[80:83], a[40:43], v[144:147], v[80:83]
    buffer_load_dwordx4 v[140:143], v17, s[16:19], s45 offen offset:1024 sc1
    v_mfma_f32_16x16x32_bf16 v[84:87], a[44:47], v[144:147], v[84:87]
    v_mfma_f32_16x16x32_bf16 v[88:91], a[40:43], v[148:151], v[88:91]
    v_mfma_f32_16x16x32_bf16 v[92:95], a[44:47], v[148:151], v[92:95]
    s_waitcnt vmcnt(11)
    v_mfma_f32_16x16x32_bf16 v[64:67], a[48:51], v[152:155], v[64:67]
    buffer_load_dwordx4 v[144:147], v16, s[16:19], s45 offen offset:2048 sc1
    v_mfma_f32_16x16x32_bf16 v[68:71], a[52:55], v[152:155], v[68:71]
    s_waitcnt vmcnt(11)
    v_mfma_f32_16x16x32_bf16 v[72:75], a[48:51], v[156:159], v[72:75]
    v_mfma_f32_16x16x32_bf16 v[76:79], a[52:55], v[156:159], v[76:79]
    v_mfma_f32_16x16x32_bf16 v[80:83], a[56:59], v[152:155], v[80:83]
    buffer_load_dwordx4 v[148:151], v17, s[16:19], s45 offen offset:3072 sc1
    s_add_u32 s45, s45, 4096
    s_and_b32 s45, s45, 0x7fff
    v_mfma_f32_16x16x32_bf16 v[84:87], a[60:63], v[152:155], v[84:87]
    v_mfma_f32_16x16x32_bf16 v[88:91], a[56:59], v[156:159], v[88:91]
    v_mfma_f32_16x16x32_bf16 v[92:95], a[60:63], v[156:159], v[92:95]
    s_waitcnt vmcnt(11)
    v_mfma_f32_16x16x32_bf16 v[64:67], a[64:67], v[160:163], v[64:67]
    buffer_load_dwordx4 v[152:155], v16, s[16:19], s45 offen offset:0 sc1
    v_mfma_f32_16x16x32_bf16 v[68:71], a[68:71], v[160:163], v[68:71]
    s_waitcnt vmcnt(11)
    v_mfma_f32_16x16x32_bf16 v[72:75], a[64:67], v[164:167], v[72:75]
    v_mfma_f32_16x16x32_bf16 v[76:79], a[68:71], v[164:167], v[76:79]
    v_mfma_f32_16x16x32_bf16 v[80:83], a[72:75], v[160:163], v[80:83]
    buffer_load_dwordx4 v[156:159], v17, s[16:19], s45 offen offset:1024 sc1
    v_mfma_f32_16x16x32_bf16 v[84:87], a[76:79], v[160:163], v[84:87]
    v_mfma_f32_16x16x32_bf16 v[88:91], a[72:75], v[164:167], v[88:91]
    v_mfma_f32_16x16x32_bf16 v[92:95], a[76:79], v[164:167], v[92:95]
    s_waitcnt vmcnt(11)
    v_mfma_f32_16x16x32_bf16 v[64:67], a[80:83], v[168:171], v[64:67]
    buffer_load_dwordx4 v[160:163], v16, s[16:19], s45 offen offset:2048 sc1
    v_mfma_f32_16x16x32_bf16 v[68:71], a[84:87], v[168:171], v[68:71]
    s_waitcnt vmcnt(11)
    v_mfma_f32_16x16x32_bf16 v[72:75], a[80:83], v[172:175], v[72:75]
    v_mfma_f32_16x16x32_bf16 v[76:79], a[84:87], v[172:175], v[76:79]
    v_mfma_f32_16x16x32_bf16 v[80:83], a[88:91], v[168:171], v[80:83]
    buffer_load_dwordx4 v[164:167], v17, s[16:19], s45 offen offset:3072 sc1
    s_add_u32 s45, s45, 4096
    s_and_b32 s45, s45, 0x7fff
    v_mfma_f32_16x16x32_bf16 v[84:87], a[92:95], v[168:171], v[84:87]
    v_mfma_f32_16x16x32_bf16 v[88:91], a[88:91], v[172:175], v[88:91]
    v_mfma_f32_16x16x32_bf16 v[92:95], a[92:95], v[172:175], v[92:95]
    s_waitcnt vmcnt(11)
    v_mfma_f32_16x16x32_bf16 v[64:67], a[96:99], v[176:179], v[64:67]
    buffer_load_dwordx4 v[168:171], v16, s[16:19], s45 offen offset:0 sc1
    v_mfma_f32_16x16x32_bf16 v[68:71], a[100:103], v[176:179], v[68:71]
    s_waitcnt vmcnt(11)
    v_mfma_f32_16x16x32_bf16 v[72:75], a[96:99], v[180:183], v[72:75]
    v_mfma_f32_16x16x32_bf16 v[76:79], a[100:103], v[180:183], v[76:79]
    v_mfma_f32_16x16x32_bf16 v[80:83], a[104:107], v[176:179], v[80:83]
    buffer_load_dwordx4 v[172:175], v17, s[16:19], s45 offen offset:1024 sc1
    v_mfma_f32_16x16x32_bf16 v[84:87], a[108:111], v[176:179], v[84:87]
    v_mfma_f32_16x16x32_bf16 v[88:91], a[104:107], v[180:183], v[88:91]
    v_mfma_f32_16x16x32_bf16 v[92:95], a[108:111], v[180:183], v[92:95]
    s_waitcnt vmcnt(11)
    v_mfma_f32_16x16x32_bf16 v[64:67], a[112:115], v[128:131], v[64:67]
    buffer_load_dwordx4 v[176:179], v16, s[16:19], s45 offen offset:2048 sc1
    v_mfma_f32_16x16x32_bf16 v[68:71], a[116:119], v[128:131], v[68:71]
    s_waitcnt vmcnt(11)
    v_mfma_f32_16x16x32_bf16 v[72:75], a[112:115], v[132:135], v[72:75]
    v_mfma_f32_16x16x32_bf16 v[76:79], a[116:119], v[132:135], v[76:79]
    v_mfma_f32_16x16x32_bf16 v[80:83], a[120:123], v[128:131], v[80:83]
    buffer_load_dwordx4 v[180:183], v17, s[16:19], s45 offen offset:3072 sc1
    s_add_u32 s45, s45, 4096
    s_and_b32 s45, s45, 0x7fff
    v_mfma_f32_16x16x32_bf16 v[84:87], a[124:127], v[128:131], v[84:87]
    v_mfma_f32_16x16x32_bf16 v[88:91], a[120:123], v[132:135], v[88:91]
    v_mfma_f32_16x16x32_bf16 v[92:95], a[124:127], v[132:135], v[92:95]
    s_waitcnt vmcnt(11) lgkmcnt(15)
    v_mfma_f32_16x16x32_bf16 v[64:67], a[128:131], v[136:139], v[64:67]
    buffer_load_dwordx4 v[128:131], v16, s[16:19], s45 offen offset:0 sc1
    v_mfma_f32_16x16x32_bf16 v[68:71], a[132:135], v[136:139], v[68:71]
    s_waitcnt vmcnt(11)
    v_mfma_f32_16x16x32_bf16 v[72:75], a[128:131], v[140:143], v[72:75]
    v_mfma_f32_16x16x32_bf16 v[76:79], a[132:135], v[140:143], v[76:79]
    v_mfma_f32_16x16x32_bf16 v[80:83], a[136:139], v[136:139], v[80:83]
    buffer_load_dwordx4 v[132:135], v17, s[16:19], s45 offen offset:1024 sc1
    v_mfma_f32_16x16x32_bf16 v[84:87], a[140:143], v[136:139], v[84:87]
    v_mfma_f32_16x16x32_bf16 v[88:91], a[136:139], v[140:143], v[88:91]
    v_mfma_f32_16x16x32_bf16 v[92:95], a[140:143], v[140:143], v[92:95]
    s_waitcnt vmcnt(11)
    v_mfma_f32_16x16x32_bf16 v[64:67], a[144:147], v[144:147], v[64:67]
    buffer_load_dwordx4 v[136:139], v16, s[16:19], s45 offen offset:2048 sc1
    v_mfma_f32_16x16x32_bf16 v[68:71], a[148:151], v[144:147], v[68:71]
    s_waitcnt vmcnt(11)
    v_mfma_f32_16x16x32_bf16 v[72:75], a[144:147], v[148:151], v[72:75]
    v_mfma_f32_16x16x32_bf16 v[76:79], a[148:151], v[148:151], v[76:79]
    v_mfma_f32_16x16x32_bf16 v[80:83], a[152:155], v[144:147], v[80:83]
    buffer_load_dwordx4 v[140:143], v17, s[16:19], s45 offen offset:3072 sc1
    s_add_u32 s45, s45, 4096
    s_and_b32 s45, s45, 0x7fff
    v_mfma_f32_16x16x32_bf16 v[84:87], a[156:159], v[144:147], v[84:87]
    v_mfma_f32_16x16x32_bf16 v[88:91], a[152:155], v[148:151], v[88:91]
    v_mfma_f32_16x16x32_bf16 v[92:95], a[156:159], v[148:151], v[92:95]
    s_waitcnt vmcnt(11)
    v_mfma_f32_16x16x32_bf16 v[64:67], a[160:163], v[152:155], v[64:67]
    buffer_load_dwordx4 v[144:147], v18, s[16:19], s45 offen offset:0 sc1
    v_mfma_f32_16x16x32_bf16 v[68:71], a[164:167], v[152:155], v[68:71]
    s_waitcnt vmcnt(11)
    v_mfma_f32_16x16x32_bf16 v[72:75], a[160:163], v[156:159], v[72:75]
    v_mfma_f32_16x16x32_bf16 v[76:79], a[164:167], v[156:159], v[76:79]
    v_mfma_f32_16x16x32_bf16 v[80:83], a[168:171], v[152:155], v[80:83]
    buffer_load_dwordx4 v[148:151], v19, s[16:19], s45 offen offset:1024 sc1
    v_mfma_f32_16x16x32_bf16 v[84:87], a[172:175], v[152:155], v[84:87]
    v_mfma_f32_16x16x32_bf16 v[88:91], a[168:171], v[156:159], v[88:91]
    v_mfma_f32_16x16x32_bf16 v[92:95], a[172:175], v[156:159], v[92:95]
    s_waitcnt vmcnt(11)
    v_mfma_f32_16x16x32_bf16 v[64:67], a[176:179], v[160:163], v[64:67]
    buffer_load_dwordx4 v[152:155], v18, s[16:19], s45 offen offset:2048 sc1
    v_mfma_f32_16x16x32_bf16 v[68:71], a[180:183], v[160:163], v[68:71]
    s_waitcnt vmcnt(11)
    v_mfma_f32_16x16x32_bf16 v[72:75], a[176:179], v[164:167], v[72:75]
    v_mfma_f32_16x16x32_bf16 v[76:79], a[180:183], v[164:167], v[76:79]
    v_mfma_f32_16x16x32_bf16 v[80:83], a[184:187], v[160:163], v[80:83]
    buffer_load_dwordx4 v[156:159], v19, s[16:19], s45 offen offset:3072 sc1
    s_add_u32 s45, s45, 4096
    s_and_b32 s45, s45, 0x7fff
    v_mfma_f32_16x16x32_bf16 v[84:87], a[188:191], v[160:163], v[84:87]
    v_mfma_f32_16x16x32_bf16 v[88:91], a[184:187], v[164:167], v[88:91]
    v_mfma_f32_16x16x32_bf16 v[92:95], a[188:191], v[164:167], v[92:95]
    s_waitcnt vmcnt(11)
    v_mfma_f32_16x16x32_bf16 v[64:67], a[192:195], v[168:171], v[64:67]
    buffer_load_dwordx4 v[160:163], v18, s[16:19], s45 offen offset:0 sc1
    v_mfma_f32_16x16x32_bf16 v[68:71], a[196:199], v[168:171], v[68:71]
    s_waitcnt vmcnt(11)
    v_mfma_f32_16x16x32_bf16 v[72:75], a[192:195], v[172:175], v[72:75]
    v_mfma_f32_16x16x32_bf16 v[76:79], a[196:199], v[172:175], v[76:79]
    v_mfma_f32_16x16x32_bf16 v[80:83], a[200:203], v[168:171], v[80:83]
    buffer_load_dwordx4 v[164:167], v19, s[16:19], s45 offen offset:1024 sc1
    v_mfma_f32_16x16x32_bf16 v[84:87], a[204:207], v[168:171], v[84:87]
    v_mfma_f32_16x16x32_bf16 v[88:91], a[200:203], v[172:175], v[88:91]
    v_mfma_f32_16x16x32_bf16 v[92:95], a[204:207], v[172:175], v[92:95]
    s_waitcnt vmcnt(11)
    v_mfma_f32_16x16x32_bf16 v[64:67], a[208:211], v[176:179], v[64:67]
    buffer_load_dwordx4 v[168:171], v18, s[16:19], s45 offen offset:2048 sc1
    v_mfma_f32_16x16x32_bf16 v[68:71], a[212:215], v[176:179], v[68:71]
    s_waitcnt vmcnt(11)
    v_mfma_f32_16x16x32_bf16 v[72:75], a[208:211], v[180:183], v[72:75]
    v_mfma_f32_16x16x32_bf16 v[76:79], a[212:215], v[180:183], v[76:79]
    v_mfma_f32_16x16x32_bf16 v[80:83], a[216:219], v[176:179], v[80:83]
    buffer_load_dwordx4 v[172:175], v19, s[16:19], s45 offen offset:3072 sc1
    s_add_u32 s45, s45, 4096
    s_and_b32 s45, s45, 0x7fff
    v_mfma_f32_16x16x32_bf16 v[84:87], a[220:223], v[176:179], v[84:87]
    v_mfma_f32_16x16x32_bf16 v[88:91], a[216:219], v[180:183], v[88:91]
    v_mfma_f32_16x16x32_bf16 v[92:95], a[220:223], v[180:183], v[92:95]
    s_waitcnt vmcnt(11) lgkmcnt(14)
    v_mfma_f32_16x16x32_bf16 v[64:67], a[224:227], v[128:131], v[64:67]
    buffer_load_dwordx4 v[176:179], v18, s[16:19], s45 offen offset:0 sc1
    s_waitcnt lgkmcnt(12)
    v_mfma_f32_16x16x32_bf16 v[68:71], a[228:231], v[128:131], v[68:71]
    s_waitcnt vmcnt(11)
    v_mfma_f32_16x16x32_bf16 v[72:75], a[224:227], v[132:135], v[72:75]
    v_mfma_f32_16x16x32_bf16 v[76:79], a[228:231], v[132:135], v[76:79]
    s_waitcnt lgkmcnt(10)
    v_mfma_f32_16x16x32_bf16 v[80:83], a[232:235], v[128:131], v[80:83]
    buffer_load_dwordx4 v[180:183], v19, s[16:19], s45 offen offset:1024 sc1
    s_waitcnt lgkmcnt(8)
    v_mfma_f32_16x16x32_bf16 v[84:87], a[236:239], v[128:131], v[84:87]
    v_mfma_f32_16x16x32_bf16 v[88:91], a[232:235], v[132:135], v[88:91]
    v_mfma_f32_16x16x32_bf16 v[92:95], a[236:239], v[132:135], v[92:95]
    s_waitcnt vmcnt(11) lgkmcnt(6)
    v_mfma_f32_16x16x32_bf16 v[64:67], a[240:243], v[136:139], v[64:67]
    buffer_load_dwordx4 v[128:131], v18, s[16:19], s45 offen offset:2048 sc1
    s_waitcnt lgkmcnt(4)
    v_mfma_f32_16x16x32_bf16 v[68:71], a[244:247], v[136:139], v[68:71]
    s_waitcnt vmcnt(11)
    v_mfma_f32_16x16x32_bf16 v[72:75], a[240:243], v[140:143], v[72:75]
    v_mfma_f32_16x16x32_bf16 v[76:79], a[244:247], v[140:143], v[76:79]
    s_waitcnt lgkmcnt(2)
    v_mfma_f32_16x16x32_bf16 v[80:83], a[248:251], v[136:139], v[80:83]
    buffer_load_dwordx4 v[132:135], v19, s[16:19], s45 offen offset:3072 sc1
    s_add_u32 s45, s45, 4096
    s_and_b32 s45, s45, 0x7fff
    s_waitcnt lgkmcnt(0)
    v_mfma_f32_16x16x32_bf16 v[84:87], a[252:255], v[136:139], v[84:87]
    v_mfma_f32_16x16x32_bf16 v[88:91], a[248:251], v[140:143], v[88:91]
    v_mfma_f32_16x16x32_bf16 v[92:95], a[252:255], v[140:143], v[92:95]
    s_waitcnt vmcnt(11)
    v_mfma_f32_16x16x32_bf16 v[96:99], a[0:3], v[144:147], 0
    buffer_load_dwordx4 v[136:139], v18, s[16:19], s45 offen offset:0 sc1
    v_mfma_f32_16x16x32_bf16 v[100:103], a[4:7], v[144:147], 0
    s_waitcnt vmcnt(11)
    v_mfma_f32_16x16x32_bf16 v[104:107], a[0:3], v[148:151], 0
    v_mfma_f32_16x16x32_bf16 v[108:111], a[4:7], v[148:151], 0
    v_mfma_f32_16x16x32_bf16 v[112:115], a[8:11], v[144:147], 0
    buffer_load_dwordx4 v[140:143], v19, s[16:19], s45 offen offset:1024 sc1
    v_mfma_f32_16x16x32_bf16 v[116:119], a[12:15], v[144:147], 0
    v_mfma_f32_16x16x32_bf16 v[120:123], a[8:11], v[148:151], 0
    ds_write_b128 v20, v[72:75] offset:0
    v_mfma_f32_16x16x32_bf16 v[124:127], a[12:15], v[148:151], 0
    s_waitcnt vmcnt(11)
    v_mfma_f32_16x16x32_bf16 v[96:99], a[16:19], v[152:155], v[96:99]
    buffer_load_dwordx4 v[144:147], v18, s[16:19], s45 offen offset:2048 sc1
    v_mfma_f32_16x16x32_bf16 v[100:103], a[20:23], v[152:155], v[100:103]
    ds_write_b128 v20, v[76:79] offset:1024
    s_waitcnt vmcnt(11)
    v_mfma_f32_16x16x32_bf16 v[104:107], a[16:19], v[156:159], v[104:107]
    v_mfma_f32_16x16x32_bf16 v[108:111], a[20:23], v[156:159], v[108:111]
    v_mfma_f32_16x16x32_bf16 v[112:115], a[24:27], v[152:155], v[112:115]
    buffer_load_dwordx4 v[148:151], v19, s[16:19], s45 offen offset:3072 sc1
    s_add_u32 s45, s45, 4096
    s_and_b32 s45, s45, 0x7fff
    ds_write_b128 v21, v[80:83] offset:0
    v_mfma_f32_16x16x32_bf16 v[116:119], a[28:31], v[152:155], v[116:119]
    v_mfma_f32_16x16x32_bf16 v[120:123], a[24:27], v[156:159], v[120:123]
    v_mfma_f32_16x16x32_bf16 v[124:127], a[28:31], v[156:159], v[124:127]
    ds_write_b128 v21, v[84:87] offset:1024
    s_waitcnt vmcnt(11)
    v_mfma_f32_16x16x32_bf16 v[96:99], a[32:35], v[160:163], v[96:99]
    buffer_load_dwordx4 v[152:155], v18, s[16:19], s45 offen offset:0 sc1
    v_mfma_f32_16x16x32_bf16 v[100:103], a[36:39], v[160:163], v[100:103]
    s_waitcnt vmcnt(11)
    v_mfma_f32_16x16x32_bf16 v[104:107], a[32:35], v[164:167], v[104:107]
    ds_write_b128 v22, v[88:91] offset:0
    v_mfma_f32_16x16x32_bf16 v[108:111], a[36:39], v[164:167], v[108:111]
    v_mfma_f32_16x16x32_bf16 v[112:115], a[40:43], v[160:163], v[112:115]
    buffer_load_dwordx4 v[156:159], v19, s[16:19], s45 offen offset:1024 sc1
    v_mfma_f32_16x16x32_bf16 v[116:119], a[44:47], v[160:163], v[116:119]
    ds_write_b128 v22, v[92:95] offset:1024
    v_mfma_f32_16x16x32_bf16 v[120:123], a[40:43], v[164:167], v[120:123]
    v_mfma_f32_16x16x32_bf16 v[124:127], a[44:47], v[164:167], v[124:127]
    s_waitcnt vmcnt(11)
    v_mfma_f32_16x16x32_bf16 v[96:99], a[48:51], v[168:171], v[96:99]
    buffer_load_dwordx4 v[160:163], v18, s[16:19], s45 offen offset:2048 sc1
    s_waitcnt lgkmcnt(0)
    v_mfma_f32_16x16x32_bf16 v[100:103], a[52:55], v[168:171], v[100:103]
    s_waitcnt vmcnt(11)
    v_mfma_f32_16x16x32_bf16 v[104:107], a[48:51], v[172:175], v[104:107]
    s_barrier
    v_mfma_f32_16x16x32_bf16 v[108:111], a[52:55], v[172:175], v[108:111]
    ds_read_b128 v[72:75], v23 offset:0
    v_mfma_f32_16x16x32_bf16 v[112:115], a[56:59], v[168:171], v[112:115]
    buffer_load_dwordx4 v[164:167], v19, s[16:19], s45 offen offset:3072 sc1
    s_add_u32 s45, s45, 4096
    s_and_b32 s45, s45, 0x7fff
    v_mfma_f32_16x16x32_bf16 v[116:119], a[60:63], v[168:171], v[116:119]
    ds_read_b128 v[76:79], v23 offset:1024
    v_mfma_f32_16x16x32_bf16 v[120:123], a[56:59], v[172:175], v[120:123]
    ds_read_b128 v[80:83], v23 offset:2048
    v_mfma_f32_16x16x32_bf16 v[124:127], a[60:63], v[172:175], v[124:127]
    s_waitcnt vmcnt(11)
    v_mfma_f32_16x16x32_bf16 v[96:99], a[64:67], v[176:179], v[96:99]
    buffer_load_dwordx4 v[168:171], v18, s[16:19], s45 offen offset:0 sc1
    ds_read_b128 v[84:87], v23 offset:3072
    v_mfma_f32_16x16x32_bf16 v[100:103], a[68:71], v[176:179], v[100:103]
    ds_read_b128 v[88:91], v23 offset:4096
    s_waitcnt vmcnt(11)
    v_mfma_f32_16x16x32_bf16 v[104:107], a[64:67], v[180:183], v[104:107]
    v_mfma_f32_16x16x32_bf16 v[108:111], a[68:71], v[180:183], v[108:111]
    ds_read_b128 v[92:95], v23 offset:5120
    v_mfma_f32_16x16x32_bf16 v[112:115], a[72:75], v[176:179], v[112:115]
    buffer_load_dwordx4 v[172:175], v19, s[16:19], s45 offen offset:1024 sc1
    v_mfma_f32_16x16x32_bf16 v[116:119], a[76:79], v[176:179], v[116:119]
    v_mfma_f32_16x16x32_bf16 v[120:123], a[72:75], v[180:183], v[120:123]
    v_mfma_f32_16x16x32_bf16 v[124:127], a[76:79], v[180:183], v[124:127]
    s_waitcnt vmcnt(11)
    v_mfma_f32_16x16x32_bf16 v[96:99], a[80:83], v[128:131], v[96:99]
    buffer_load_dwordx4 v[176:179], v18, s[16:19], s45 offen offset:2048 sc1
    v_mfma_f32_16x16x32_bf16 v[100:103], a[84:87], v[128:131], v[100:103]
    s_waitcnt lgkmcnt(0)
    s_waitcnt vmcnt(11)
    v_mfma_f32_16x16x32_bf16 v[104:107], a[80:83], v[132:135], v[104:107]
    v_mfma_f32_16x16x32_bf16 v[108:111], a[84:87], v[132:135], v[108:111]
    s_barrier
    v_mfma_f32_16x16x32_bf16 v[112:115], a[88:91], v[128:131], v[112:115]
    buffer_load_dwordx4 v[180:183], v19, s[16:19], s45 offen offset:3072 sc1
    s_add_u32 s45, s45, 4096
    s_and_b32 s45, s45, 0x7fff
    v_mfma_f32_16x16x32_bf16 v[116:119], a[92:95], v[128:131], v[116:119]
    v_mfma_f32_16x16x32_bf16 v[120:123], a[88:91], v[132:135], v[120:123]
    v_mfma_f32_16x16x32_bf16 v[124:127], a[92:95], v[132:135], v[124:127]
    s_waitcnt vmcnt(11)
    v_mfma_f32_16x16x32_bf16 v[96:99], a[96:99], v[136:139], v[96:99]
    buffer_load_dwordx4 v[128:131], v18, s[16:19], s45 offen offset:0 sc1
    v_mfma_f32_16x16x32_bf16 v[100:103], a[100:103], v[136:139], v[100:103]
    s_waitcnt vmcnt(11)
    v_mfma_f32_16x16x32_bf16 v[104:107], a[96:99], v[140:143], v[104:107]
    v_mfma_f32_16x16x32_bf16 v[108:111], a[100:103], v[140:143], v[108:111]
    v_mfma_f32_16x16x32_bf16 v[112:115], a[104:107], v[136:139], v[112:115]
    buffer_load_dwordx4 v[132:135], v19, s[16:19], s45 offen offset:1024 sc1
    v_mfma_f32_16x16x32_bf16 v[116:119], a[108:111], v[136:139], v[116:119]
    v_mfma_f32_16x16x32_bf16 v[120:123], a[104:107], v[140:143], v[120:123]
    v_mfma_f32_16x16x32_bf16 v[124:127], a[108:111], v[140:143], v[124:127]
    s_waitcnt vmcnt(11)
    v_mfma_f32_16x16x32_bf16 v[96:99], a[112:115], v[144:147], v[96:99]
    buffer_load_dwordx4 v[136:139], v18, s[16:19], s45 offen offset:2048 sc1
    v_mfma_f32_16x16x32_bf16 v[100:103], a[116:119], v[144:147], v[100:103]
    s_waitcnt vmcnt(11)
    v_mfma_f32_16x16x32_bf16 v[104:107], a[112:115], v[148:151], v[104:107]
    v_mfma_f32_16x16x32_bf16 v[108:111], a[116:119], v[148:151], v[108:111]
    v_mfma_f32_16x16x32_bf16 v[112:115], a[120:123], v[144:147], v[112:115]
    buffer_load_dwordx4 v[140:143], v19, s[16:19], s45 offen offset:3072 sc1
    s_add_u32 s45, s45, 4096
    s_and_b32 s45, s45, 0x7fff
    v_mfma_f32_16x16x32_bf16 v[116:119], a[124:127], v[144:147], v[116:119]
    v_mfma_f32_16x16x32_bf16 v[120:123], a[120:123], v[148:151], v[120:123]
    v_add_f32 v64, v64, v72
    v_add_f32 v65, v65, v73
    v_add_f32 v66, v66, v74
    v_mfma_f32_16x16x32_bf16 v[124:127], a[124:127], v[148:151], v[124:127]
    v_add_f32 v67, v67, v75
    v_add_f32 v68, v68, v76
    s_waitcnt vmcnt(11)
    v_mfma_f32_16x16x32_bf16 v[96:99], a[128:131], v[152:155], v[96:99]
    buffer_load_dwordx4 v[144:147], v18, s[16:19], s45 offen offset:0 sc1
    v_add_f32 v69, v69, v77
    v_add_f32 v70, v70, v78
    v_mfma_f32_16x16x32_bf16 v[100:103], a[132:135], v[152:155], v[100:103]
    v_add_f32 v71, v71, v79
    v_add_f32 v80, v80, v88
    s_waitcnt vmcnt(11)
    v_mfma_f32_16x16x32_bf16 v[104:107], a[128:131], v[156:159], v[104:107]
    v_add_f32 v81, v81, v89
    v_add_f32 v82, v82, v90
    v_mfma_f32_16x16x32_bf16 v[108:111], a[132:135], v[156:159], v[108:111]
    v_add_f32 v83, v83, v91
    v_add_f32 v84, v84, v92
    v_mfma_f32_16x16x32_bf16 v[112:115], a[136:139], v[152:155], v[112:115]
    buffer_load_dwordx4 v[148:151], v19, s[16:19], s45 offen offset:1024 sc1
    v_add_f32 v85, v85, v93
    v_add_f32 v86, v86, v94
    v_mfma_f32_16x16x32_bf16 v[116:119], a[140:143], v[152:155], v[116:119]
    v_add_f32 v87, v87, v95
    v_add_f32 v64, v64, v80
    v_mfma_f32_16x16x32_bf16 v[120:123], a[136:139], v[156:159], v[120:123]
    v_add_f32 v65, v65, v81
    v_add_f32 v66, v66, v82
    v_mfma_f32_16x16x32_bf16 v[124:127], a[140:143], v[156:159], v[124:127]
    v_add_f32 v67, v67, v83
    v_add_f32 v68, v68, v84
    s_waitcnt vmcnt(11)
    v_mfma_f32_16x16x32_bf16 v[96:99], a[144:147], v[160:163], v[96:99]
    buffer_load_dwordx4 v[152:155], v18, s[16:19], s45 offen offset:2048 sc1
    v_add_f32 v69, v69, v85
    v_add_f32 v70, v70, v86
    v_mfma_f32_16x16x32_bf16 v[100:103], a[148:151], v[160:163], v[100:103]
    v_add_f32 v71, v71, v87
    v_cvt_pk_bf16_f32 v64, 0, v64
    s_waitcnt vmcnt(11)
    v_mfma_f32_16x16x32_bf16 v[104:107], a[144:147], v[164:167], v[104:107]
    v_cvt_pk_bf16_f32 v65, 0, v65
    v_cvt_pk_bf16_f32 v66, 0, v66
    v_mfma_f32_16x16x32_bf16 v[108:111], a[148:151], v[164:167], v[108:111]
    v_cvt_pk_bf16_f32 v67, 0, v67
    v_cvt_pk_bf16_f32 v68, 0, v68
    v_mfma_f32_16x16x32_bf16 v[112:115], a[152:155], v[160:163], v[112:115]
    buffer_load_dwordx4 v[156:159], v19, s[16:19], s45 offen offset:3072 sc1
    s_add_u32 s45, s45, 4096
    s_and_b32 s45, s45, 0x7fff
    v_cvt_pk_bf16_f32 v69, 0, v69
    v_cvt_pk_bf16_f32 v70, 0, v70
    v_mfma_f32_16x16x32_bf16 v[116:119], a[156:159], v[160:163], v[116:119]
    v_cvt_pk_bf16_f32 v71, 0, v71
    v_add_f32 v64, v64, v24
    v_mfma_f32_16x16x32_bf16 v[120:123], a[152:155], v[164:167], v[120:123]
    v_add_f32 v65, v65, v25
    v_add_f32 v66, v66, v26
    v_mfma_f32_16x16x32_bf16 v[124:127], a[156:159], v[164:167], v[124:127]
    v_add_f32 v67, v67, v27
    v_add_f32 v68, v68, v28
    s_waitcnt vmcnt(10)
    v_mfma_f32_16x16x32_bf16 v[104:107], a[160:163], v[172:175], v[104:107]
    v_add_f32 v69, v69, v29
    v_add_f32 v70, v70, v30
    v_add_f32 v71, v71, v31
    v_mfma_f32_16x16x32_bf16 v[108:111], a[164:167], v[172:175], v[108:111]
    s_add_u32 m0, s42, 0
    s_mul_i32 s47, s52, s54
    buffer_load_dwordx4 v8, s[12:15], s47 offen offset:0 lds
    s_add_u32 s52, s52, 1
    s_cmp_eq_u32 s52, s53
    s_cselect_b32 s52, 0, s52
    v_cvt_pk_bf16_f32 v64, 0, v64
    v_cvt_pk_bf16_f32 v65, 0, v65
    v_cvt_pk_bf16_f32 v66, 0, v66
    v_mfma_f32_16x16x32_bf16 v[112:115], a[168:171], v[168:171], v[112:115]
    v_cvt_pk_bf16_f32 v67, 0, v67
    v_cvt_pk_bf16_f32 v68, 0, v68
    v_cvt_pk_bf16_f32 v69, 0, v69
    v_mfma_f32_16x16x32_bf16 v[116:119], a[172:175], v[168:171], v[116:119]
    buffer_load_dwordx4 v[208:211], v36, s[4:7], 0 offen offset:0
    buffer_load_dwordx4 v[220:223], v36, s[4:7], 0 offen offset:64
    v_cvt_pk_bf16_f32 v70, 0, v70
    v_cvt_pk_bf16_f32 v71, 0, v71
    v_mul_f32 v72, v64, v64
    v_mfma_f32_16x16x32_bf16 v[120:123], a[168:171], v[172:175], v[120:123]
    v_mul_f32 v73, v65, v65
    v_mul_f32 v74, v66, v66
    v_mul_f32 v75, v67, v67
    v_mfma_f32_16x16x32_bf16 v[124:127], a[172:175], v[172:175], v[124:127]
    buffer_load_dwordx4 v9, s[12:15], s47 offen offset:1024 lds
    v_mul_f32 v76, v68, v68
    v_mul_f32 v77, v69, v69
    v_mul_f32 v78, v70, v70
    s_waitcnt vmcnt(12)
    v_mfma_f32_16x16x32_bf16 v[104:107], a[176:179], v[180:183], v[104:107]
    v_mul_f32 v79, v71, v71
    v_mov_b32 v80, 0xc0135761
    v_fmamk_f32 v72, v72, 0xbdd2d3e8, v80
    v_mfma_f32_16x16x32_bf16 v[108:111], a[180:183], v[180:183], v[108:111]
    v_fmamk_f32 v73, v73, 0xbdd2d3e8, v80
    v_fmamk_f32 v74, v74, 0xbdd2d3e8, v80
    v_fmamk_f32 v75, v75, 0xbdd2d3e8, v80
    v_mfma_f32_16x16x32_bf16 v[112:115], a[184:187], v[176:179], v[112:115]
    v_fmamk_f32 v76, v76, 0xbdd2d3e8, v80
    v_fmamk_f32 v77, v77, 0xbdd2d3e8, v80
    v_fmamk_f32 v78, v78, 0xbdd2d3e8, v80
    v_mfma_f32_16x16x32_bf16 v[116:119], a[188:191], v[176:179], v[116:119]
    buffer_load_dwordx4 v10, s[12:15], s47 offen offset:2048 lds
    v_fmamk_f32 v79, v79, 0xbdd2d3e8, v80
    v_mul_f32 v72, v72, v64
    v_mul_f32 v73, v73, v65
    v_mfma_f32_16x16x32_bf16 v[120:123], a[184:187], v[180:183], v[120:123]
    v_mul_f32 v74, v74, v66
    v_mul_f32 v75, v75, v67
    v_mul_f32 v76, v76, v68
    v_mfma_f32_16x16x32_bf16 v[124:127], a[188:191], v[180:183], v[124:127]
    v_mul_f32 v77, v77, v69
    v_mul_f32 v78, v78, v70
    v_mul_f32 v79, v79, v71
    s_waitcnt vmcnt(11)
    v_mfma_f32_16x16x32_bf16 v[104:107], a[192:195], v[132:135], v[104:107]
    v_mfma_f32_16x16x32_bf16 v[108:111], a[196:199], v[132:135], v[108:111]
    buffer_load_dwordx4 v11, s[12:15], s47 offen offset:3072 lds
    v_mfma_f32_16x16x32_bf16 v[112:115], a[200:203], v[128:131], v[112:115]
    v_mfma_f32_16x16x32_bf16 v[116:119], a[204:207], v[128:131], v[116:119]
    v_mfma_f32_16x16x32_bf16 v[120:123], a[200:203], v[132:135], v[120:123]
    v_mfma_f32_16x16x32_bf16 v[124:127], a[204:207], v[132:135], v[124:127]
    s_add_u32 m0, s42, 4096
    s_add_u32 s47, s47, s55
    buffer_load_dwordx4 v8, s[12:15], s47 offen offset:0 lds
    s_waitcnt vmcnt(11)
    v_mfma_f32_16x16x32_bf16 v[104:107], a[208:211], v[140:143], v[104:107]
    v_mfma_f32_16x16x32_bf16 v[108:111], a[212:215], v[140:143], v[108:111]
    v_mfma_f32_16x16x32_bf16 v[112:115], a[216:219], v[136:139], v[112:115]
    v_mfma_f32_16x16x32_bf16 v[116:119], a[220:223], v[136:139], v[116:119]
    buffer_load_dwordx4 v9, s[12:15], s47 offen offset:1024 lds
    v_mfma_f32_16x16x32_bf16 v[120:123], a[216:219], v[140:143], v[120:123]
    v_mfma_f32_16x16x32_bf16 v[124:127], a[220:223], v[140:143], v[124:127]
    s_waitcnt vmcnt(10)
    v_mfma_f32_16x16x32_bf16 v[104:107], a[224:227], v[148:151], v[104:107]
    v_mfma_f32_16x16x32_bf16 v[108:111], a[228:231], v[148:151], v[108:111]
    buffer_load_dwordx4 v10, s[12:15], s47 offen offset:2048 lds
    v_mfma_f32_16x16x32_bf16 v[112:115], a[232:235], v[144:147], v[112:115]
    v_mfma_f32_16x16x32_bf16 v[116:119], a[236:239], v[144:147], v[116:119]
    v_mfma_f32_16x16x32_bf16 v[120:123], a[232:235], v[148:151], v[120:123]
    v_mfma_f32_16x16x32_bf16 v[124:127], a[236:239], v[148:151], v[124:127]
    buffer_load_dwordx4 v11, s[12:15], s47 offen offset:3072 lds
    s_waitcnt vmcnt(10)
    v_mfma_f32_16x16x32_bf16 v[104:107], a[240:243], v[156:159], v[104:107]
    v_mfma_f32_16x16x32_bf16 v[108:111], a[244:247], v[156:159], v[108:111]
    v_mfma_f32_16x16x32_bf16 v[112:115], a[248:251], v[152:155], v[112:115]
    v_mfma_f32_16x16x32_bf16 v[116:119], a[252:255], v[152:155], v[116:119]
    v_mfma_f32_16x16x32_bf16 v[120:123], a[248:251], v[156:159], v[120:123]
    v_mfma_f32_16x16x32_bf16 v[124:127], a[252:255], v[156:159], v[124:127]
    v_mfma_f32_16x16x32_bf16 v[96:99], a[160:163], v[168:171], v[96:99]
    v_mfma_f32_16x16x32_bf16 v[100:103], a[164:167], v[168:171], v[100:103]
    s_nop 0
    ds_write_b128 v20, v[104:107] offset:0
    v_mfma_f32_16x16x32_bf16 v[96:99], a[176:179], v[176:179], v[96:99]
    v_mfma_f32_16x16x32_bf16 v[100:103], a[180:183], v[176:179], v[100:103]
    ds_write_b128 v20, v[108:111] offset:1024
    v_mfma_f32_16x16x32_bf16 v[96:99], a[192:195], v[128:131], v[96:99]
    v_mfma_f32_16x16x32_bf16 v[100:103], a[196:199], v[128:131], v[100:103]
    ds_write_b128 v21, v[112:115] offset:0
    v_mfma_f32_16x16x32_bf16 v[96:99], a[208:211], v[136:139], v[96:99]
    v_mfma_f32_16x16x32_bf16 v[100:103], a[212:215], v[136:139], v[100:103]
    ds_write_b128 v21, v[116:119] offset:1024
    v_mfma_f32_16x16x32_bf16 v[96:99], a[224:227], v[144:147], v[96:99]
    v_mfma_f32_16x16x32_bf16 v[100:103], a[228:231], v[144:147], v[100:103]
    ds_write_b128 v22, v[120:123] offset:0
    v_mfma_f32_16x16x32_bf16 v[96:99], a[240:243], v[152:155], v[96:99]
    v_mfma_f32_16x16x32_bf16 v[100:103], a[244:247], v[152:155], v[100:103]
    ds_write_b128 v22, v[124:127] offset:1024
    v_exp_f32 v72, v72
    v_exp_f32 v73, v73
    v_exp_f32 v74, v74
    v_exp_f32 v75, v75
    v_exp_f32 v76, v76
    v_exp_f32 v77, v77
    v_exp_f32 v78, v78
    v_exp_f32 v79, v79
    v_pk_add_f32 v[72:73], v[72:73], 1.0 op_sel_hi:[1,0]
    v_pk_add_f32 v[74:75], v[74:75], 1.0 op_sel_hi:[1,0]
    v_pk_add_f32 v[76:77], v[76:77], 1.0 op_sel_hi:[1,0]
    v_pk_add_f32 v[78:79], v[78:79], 1.0 op_sel_hi:[1,0]
    v_rcp_f32 v72, v72
    v_rcp_f32 v73, v73
    v_rcp_f32 v74, v74
    v_rcp_f32 v75, v75
    v_rcp_f32 v76, v76
    v_rcp_f32 v77, v77
    v_rcp_f32 v78, v78
    v_rcp_f32 v79, v79
    v_pk_mul_f32 v[64:65], v[64:65], v[72:73]
    v_pk_mul_f32 v[66:67], v[66:67], v[74:75]
    v_pk_mul_f32 v[68:69], v[68:69], v[76:77]
    v_pk_mul_f32 v[70:71], v[70:71], v[78:79]
    v_cvt_pk_bf16_f32 v84, v64, v65
    v_cvt_pk_bf16_f32 v85, v66, v67
    v_cvt_pk_bf16_f32 v86, v68, v69
    v_cvt_pk_bf16_f32 v87, v70, v71
    s_waitcnt lgkmcnt(0)
    s_barrier
    ds_read_b128 v[104:107], v23 offset:0
    ds_read_b128 v[108:111], v23 offset:1024
    ds_read_b128 v[112:115], v23 offset:2048
    ds_read_b128 v[116:119], v23 offset:3072
    ds_read_b128 v[120:123], v23 offset:4096
    ds_read_b128 v[124:127], v23 offset:5120
    s_waitcnt lgkmcnt(5)
    v_pk_add_f32 v[96:97], v[96:97], v[104:105]
    v_pk_add_f32 v[98:99], v[98:99], v[106:107]
    s_waitcnt lgkmcnt(4)
    v_pk_add_f32 v[100:101], v[100:101], v[108:109]
    v_pk_add_f32 v[102:103], v[102:103], v[110:111]
    s_waitcnt lgkmcnt(1)
    v_pk_add_f32 v[112:113], v[112:113], v[120:121]
    v_pk_add_f32 v[114:115], v[114:115], v[122:123]
    s_waitcnt lgkmcnt(0)
    v_pk_add_f32 v[116:117], v[116:117], v[124:125]
    v_pk_add_f32 v[118:119], v[118:119], v[126:127]
    v_pk_add_f32 v[96:97], v[96:97], v[112:113]
    v_pk_add_f32 v[98:99], v[98:99], v[114:115]
    v_pk_add_f32 v[100:101], v[100:101], v[116:117]
    v_pk_add_f32 v[102:103], v[102:103], v[118:119]
    v_cvt_pk_bf16_f32 v96, 0, v96
    v_cvt_pk_bf16_f32 v97, 0, v97
    v_cvt_pk_bf16_f32 v98, 0, v98
    v_cvt_pk_bf16_f32 v99, 0, v99
    v_cvt_pk_bf16_f32 v100, 0, v100
    v_cvt_pk_bf16_f32 v101, 0, v101
    v_cvt_pk_bf16_f32 v102, 0, v102
    v_cvt_pk_bf16_f32 v103, 0, v103
    v_pk_add_f32 v[96:97], v[96:97], v[24:25]
    v_pk_add_f32 v[98:99], v[98:99], v[26:27]
    v_pk_add_f32 v[100:101], v[100:101], v[28:29]
    v_pk_add_f32 v[102:103], v[102:103], v[30:31]
    s_mov_b32 s80, 0xbdd2d3e8
    v_mov_b32 v112, 0xc0135761
    v_cvt_pk_bf16_f32 v96, 0, v96
    v_cvt_pk_bf16_f32 v97, 0, v97
    v_cvt_pk_bf16_f32 v98, 0, v98
    v_cvt_pk_bf16_f32 v99, 0, v99
    v_cvt_pk_bf16_f32 v100, 0, v100
    v_cvt_pk_bf16_f32 v101, 0, v101
    v_cvt_pk_bf16_f32 v102, 0, v102
    v_cvt_pk_bf16_f32 v103, 0, v103
    v_pk_mul_f32 v[104:105], v[96:97], v[96:97]
    v_pk_mul_f32 v[106:107], v[98:99], v[98:99]
    v_pk_mul_f32 v[108:109], v[100:101], v[100:101]
    v_pk_mul_f32 v[110:111], v[102:103], v[102:103]
    v_pk_fma_f32 v[104:105], v[104:105], s[80:81], v[112:113] op_sel_hi:[1,0,0]
    v_pk_fma_f32 v[106:107], v[106:107], s[80:81], v[112:113] op_sel_hi:[1,0,0]
    v_pk_fma_f32 v[108:109], v[108:109], s[80:81], v[112:113] op_sel_hi:[1,0,0]
    v_pk_fma_f32 v[110:111], v[110:111], s[80:81], v[112:113] op_sel_hi:[1,0,0]
    v_pk_mul_f32 v[104:105], v[104:105], v[96:97]
    v_pk_mul_f32 v[106:107], v[106:107], v[98:99]
    v_pk_mul_f32 v[108:109], v[108:109], v[100:101]
    v_pk_mul_f32 v[110:111], v[110:111], v[102:103]
    v_exp_f32 v104, v104
    v_exp_f32 v105, v105
    v_exp_f32 v106, v106
    v_exp_f32 v107, v107
    v_exp_f32 v108, v108
    v_exp_f32 v109, v109
    v_exp_f32 v110, v110
    v_exp_f32 v111, v111
    v_pk_add_f32 v[104:105], v[104:105], 1.0 op_sel_hi:[1,0]
    v_pk_add_f32 v[106:107], v[106:107], 1.0 op_sel_hi:[1,0]
    v_pk_add_f32 v[108:109], v[108:109], 1.0 op_sel_hi:[1,0]
    v_pk_add_f32 v[110:111], v[110:111], 1.0 op_sel_hi:[1,0]
    v_rcp_f32 v104, v104
    v_rcp_f32 v105, v105
    v_rcp_f32 v106, v106
    v_rcp_f32 v107, v107
    v_rcp_f32 v108, v108
    v_rcp_f32 v109, v109
    v_rcp_f32 v110, v110
    v_rcp_f32 v111, v111
    v_pk_mul_f32 v[96:97], v[96:97], v[104:105]
    v_pk_mul_f32 v[98:99], v[98:99], v[106:107]
    v_pk_mul_f32 v[100:101], v[100:101], v[108:109]
    v_pk_mul_f32 v[102:103], v[102:103], v[110:111]
    v_cvt_pk_bf16_f32 v116, v96, v97
    v_cvt_pk_bf16_f32 v117, v98, v99
    v_cvt_pk_bf16_f32 v118, v100, v101
    v_cvt_pk_bf16_f32 v119, v102, v103
    s_mov_b32 s79, 114688
    buffer_store_dwordx4 v[84:87], v35, s[16:19], 0 offen sc1
    buffer_store_dwordx4 v[116:119], v35, s[16:19], s79 offen sc1
    s_barrier
    s_lshl_b32 s45, s64, 12
    v_lshlrev_b32 v37, 16, v37
    s_add_u32 m0, s42, 8192
    s_mul_i32 s47, s52, s54
    buffer_load_dwordx4 v8, s[12:15], s47 offen offset:0 lds
    s_add_u32 s52, s52, 1
    s_cmp_eq_u32 s52, s53
    s_cselect_b32 s52, 0, s52
    buffer_load_dwordx4 v9, s[12:15], s47 offen offset:1024 lds
    buffer_load_dwordx4 v10, s[12:15], s47 offen offset:2048 lds
    buffer_load_dwordx4 v11, s[12:15], s47 offen offset:3072 lds
    s_add_u32 m0, s42, 12288
    s_add_u32 s47, s47, s55
    buffer_load_dwordx4 v8, s[12:15], s47 offen offset:0 lds
    buffer_load_dwordx4 v9, s[12:15], s47 offen offset:1024 lds
    buffer_load_dwordx4 v10, s[12:15], s47 offen offset:2048 lds
    buffer_load_dwordx4 v11, s[12:15], s47 offen offset:3072 lds
    s_waitcnt vmcnt(8)
    s_atomic_add s95, s[16:17], s58 offset:0
    s_atomic_add s95, s[16:17], s58 offset:4096
    s_atomic_add s95, s[16:17], s58 offset:8192
    s_atomic_add s95, s[16:17], s58 offset:12288
    s_add_u32 m0, s42, 16384
    s_mul_i32 s47, s52, s54
    buffer_load_dwordx4 v8, s[12:15], s47 offen offset:0 lds
    s_add_u32 s52, s52, 1
    s_cmp_eq_u32 s52, s53
    s_cselect_b32 s52, 0, s52
    ds_read_b64_tr_b16 a[0:1], v244 offset:0
    ds_read_b64_tr_b16 a[2:3], v244 offset:512
    ds_read_b64_tr_b16 a[4:5], v245 offset:0
    buffer_load_dwordx4 v9, s[12:15], s47 offen offset:1024 lds
    ds_read_b64_tr_b16 a[6:7], v245 offset:512
    ds_read_b64_tr_b16 a[8:9], v246 offset:0
    ds_read_b64_tr_b16 a[10:11], v246 offset:512
    buffer_load_dwordx4 v10, s[12:15], s47 offen offset:2048 lds
    ds_read_b64_tr_b16 a[12:13], v247 offset:0
    ds_read_b64_tr_b16 a[14:15], v247 offset:512
    buffer_load_dwordx4 v11, s[12:15], s47 offen offset:3072 lds
    ds_read_b64_tr_b16 a[16:17], v244 offset:4096
    ds_read_b64_tr_b16 a[18:19], v244 offset:4608
    ds_read_b64_tr_b16 a[20:21], v245 offset:4096
    s_add_u32 m0, s42, 20480
    s_add_u32 s47, s47, s55
    buffer_load_dwordx4 v8, s[12:15], s47 offen offset:0 lds
    ds_read_b64_tr_b16 a[22:23], v245 offset:4608
    ds_read_b64_tr_b16 a[24:25], v246 offset:4096
    ds_read_b64_tr_b16 a[26:27], v246 offset:4608
    buffer_load_dwordx4 v9, s[12:15], s47 offen offset:1024 lds
    ds_read_b64_tr_b16 a[28:29], v247 offset:4096
    ds_read_b64_tr_b16 a[30:31], v247 offset:4608
    buffer_load_dwordx4 v10, s[12:15], s47 offen offset:2048 lds
    buffer_load_dwordx4 v11, s[12:15], s47 offen offset:3072 lds
    s_waitcnt vmcnt(12)
    ds_read_b64_tr_b16 a[32:33], v244 offset:8192
    ds_read_b64_tr_b16 a[34:35], v244 offset:8704
    ds_read_b64_tr_b16 a[36:37], v245 offset:8192
    s_add_u32 m0, s42, 24576
    s_mul_i32 s47, s52, s54
    buffer_load_dwordx4 v8, s[12:15], s47 offen offset:0 lds
    s_add_u32 s52, s52, 1
    s_cmp_eq_u32 s52, s53
    s_cselect_b32 s52, 0, s52
    ds_read_b64_tr_b16 a[38:39], v245 offset:8704
    ds_read_b64_tr_b16 a[40:41], v246 offset:8192
    ds_read_b64_tr_b16 a[42:43], v246 offset:8704
    buffer_load_dwordx4 v9, s[12:15], s47 offen offset:1024 lds
    ds_read_b64_tr_b16 a[44:45], v247 offset:8192
    ds_read_b64_tr_b16 a[46:47], v247 offset:8704
    buffer_load_dwordx4 v10, s[12:15], s47 offen offset:2048 lds
    buffer_load_dwordx4 v11, s[12:15], s47 offen offset:3072 lds
    s_waitcnt vmcnt(12)
    ds_read_b64_tr_b16 a[48:49], v244 offset:12288
    ds_read_b64_tr_b16 a[50:51], v244 offset:12800
    ds_read_b64_tr_b16 a[52:53], v245 offset:12288
    s_add_u32 m0, s42, 28672
    s_add_u32 s47, s47, s55
    buffer_load_dwordx4 v8, s[12:15], s47 offen offset:0 lds
    ds_read_b64_tr_b16 a[54:55], v245 offset:12800
    ds_read_b64_tr_b16 a[56:57], v246 offset:12288
    ds_read_b64_tr_b16 a[58:59], v246 offset:12800
    buffer_load_dwordx4 v9, s[12:15], s47 offen offset:1024 lds
    ds_read_b64_tr_b16 a[60:61], v247 offset:12288
    ds_read_b64_tr_b16 a[62:63], v247 offset:12800
    buffer_load_dwordx4 v10, s[12:15], s47 offen offset:2048 lds
    buffer_load_dwordx4 v11, s[12:15], s47 offen offset:3072 lds
    s_waitcnt vmcnt(12)
    ds_read_b64_tr_b16 a[64:65], v244 offset:16384
    ds_read_b64_tr_b16 a[66:67], v244 offset:16896
    ds_read_b64_tr_b16 a[68:69], v245 offset:16384
    s_waitcnt lgkmcnt(15)
    s_add_u32 m0, s42, 0
    s_mul_i32 s47, s52, s54
    buffer_load_dwordx4 v8, s[12:15], s47 offen offset:0 lds
    s_add_u32 s52, s52, 1
    s_cmp_eq_u32 s52, s53
    s_cselect_b32 s52, 0, s52
    ds_read_b64_tr_b16 a[70:71], v245 offset:16896
    ds_read_b64_tr_b16 a[72:73], v246 offset:16384
    ds_read_b64_tr_b16 a[74:75], v246 offset:16896
    buffer_load_dwordx4 v9, s[12:15], s47 offen offset:1024 lds
    ds_read_b64_tr_b16 a[76:77], v247 offset:16384
    ds_read_b64_tr_b16 a[78:79], v247 offset:16896
    buffer_load_dwordx4 v10, s[12:15], s47 offen offset:2048 lds
    buffer_load_dwordx4 v11, s[12:15], s47 offen offset:3072 lds
    s_waitcnt vmcnt(12)
    ds_read_b64_tr_b16 a[80:81], v244 offset:20480
    ds_read_b64_tr_b16 a[82:83], v244 offset:20992
    ds_read_b64_tr_b16 a[84:85], v245 offset:20480
    s_add_u32 m0, s42, 4096
    s_add_u32 s47, s47, s55
    buffer_load_dwordx4 v8, s[12:15], s47 offen offset:0 lds
    ds_read_b64_tr_b16 a[86:87], v245 offset:20992
    ds_read_b64_tr_b16 a[88:89], v246 offset:20480
    ds_read_b64_tr_b16 a[90:91], v246 offset:20992
    buffer_load_dwordx4 v9, s[12:15], s47 offen offset:1024 lds
    ds_read_b64_tr_b16 a[92:93], v247 offset:20480
    ds_read_b64_tr_b16 a[94:95], v247 offset:20992
    buffer_load_dwordx4 v10, s[12:15], s47 offen offset:2048 lds
    buffer_load_dwordx4 v11, s[12:15], s47 offen offset:3072 lds
    s_waitcnt vmcnt(12)
    ds_read_b64_tr_b16 a[96:97], v244 offset:24576
    ds_read_b64_tr_b16 a[98:99], v244 offset:25088
    ds_read_b64_tr_b16 a[100:101], v245 offset:24576
    s_waitcnt lgkmcnt(15)
    s_add_u32 m0, s42, 8192
    s_mul_i32 s47, s52, s54
    buffer_load_dwordx4 v8, s[12:15], s47 offen offset:0 lds
    s_add_u32 s52, s52, 1
    s_cmp_eq_u32 s52, s53
    s_cselect_b32 s52, 0, s52
    ds_read_b64_tr_b16 a[102:103], v245 offset:25088
    ds_read_b64_tr_b16 a[104:105], v246 offset:24576
    ds_read_b64_tr_b16 a[106:107], v246 offset:25088
    buffer_load_dwordx4 v9, s[12:15], s47 offen offset:1024 lds
    ds_read_b64_tr_b16 a[108:109], v247 offset:24576
    ds_read_b64_tr_b16 a[110:111], v247 offset:25088
    buffer_load_dwordx4 v10, s[12:15], s47 offen offset:2048 lds
    buffer_load_dwordx4 v11, s[12:15], s47 offen offset:3072 lds
    s_waitcnt vmcnt(12)
    ds_read_b64_tr_b16 a[112:113], v244 offset:28672
    ds_read_b64_tr_b16 a[114:115], v244 offset:29184
    ds_read_b64_tr_b16 a[116:117], v245 offset:28672
    s_add_u32 m0, s42, 12288
    s_add_u32 s47, s47, s55
    buffer_load_dwordx4 v8, s[12:15], s47 offen offset:0 lds
    ds_read_b64_tr_b16 a[118:119], v245 offset:29184
    ds_read_b64_tr_b16 a[120:121], v246 offset:28672
    ds_read_b64_tr_b16 a[122:123], v246 offset:29184
    buffer_load_dwordx4 v9, s[12:15], s47 offen offset:1024 lds
    ds_read_b64_tr_b16 a[124:125], v247 offset:28672
    ds_read_b64_tr_b16 a[126:127], v247 offset:29184
    s_load_dword s94, s[16:17], s59 glc
    buffer_load_dwordx4 v10, s[12:15], s47 offen offset:2048 lds
    buffer_load_dwordx4 v11, s[12:15], s47 offen offset:3072 lds
    s_waitcnt vmcnt(12)
    ds_read_b64_tr_b16 a[128:129], v244 offset:0
    ds_read_b64_tr_b16 a[130:131], v244 offset:512
    ds_read_b64_tr_b16 a[132:133], v245 offset:0
    s_waitcnt lgkmcnt(15)
    s_add_u32 m0, s42, 16384
    s_mul_i32 s47, s52, s54
    buffer_load_dwordx4 v8, s[12:15], s47 offen offset:0 lds
    s_add_u32 s52, s52, 1
    s_cmp_eq_u32 s52, s53
    s_cselect_b32 s52, 0, s52
    ds_read_b64_tr_b16 a[134:135], v245 offset:512
    ds_read_b64_tr_b16 a[136:137], v246 offset:0
    ds_read_b64_tr_b16 a[138:139], v246 offset:512
    buffer_load_dwordx4 v9, s[12:15], s47 offen offset:1024 lds
    ds_read_b64_tr_b16 a[140:141], v247 offset:0
    ds_read_b64_tr_b16 a[142:143], v247 offset:512
    buffer_load_dwordx4 v10, s[12:15], s47 offen offset:2048 lds
    buffer_load_dwordx4 v11, s[12:15], s47 offen offset:3072 lds
    s_waitcnt vmcnt(12)
    ds_read_b64_tr_b16 a[144:145], v244 offset:4096
    ds_read_b64_tr_b16 a[146:147], v244 offset:4608
    ds_read_b64_tr_b16 a[148:149], v245 offset:4096
    s_add_u32 m0, s42, 20480
    s_add_u32 s47, s47, s55
    buffer_load_dwordx4 v8, s[12:15], s47 offen offset:0 lds
    ds_read_b64_tr_b16 a[150:151], v245 offset:4608
    ds_read_b64_tr_b16 a[152:153], v246 offset:4096
    ds_read_b64_tr_b16 a[154:155], v246 offset:4608
    buffer_load_dwordx4 v9, s[12:15], s47 offen offset:1024 lds
    ds_read_b64_tr_b16 a[156:157], v247 offset:4096
    ds_read_b64_tr_b16 a[158:159], v247 offset:4608
    buffer_load_dwordx4 v10, s[12:15], s47 offen offset:2048 lds
    buffer_load_dwordx4 v11, s[12:15], s47 offen offset:3072 lds
    s_waitcnt vmcnt(12)
    ds_read_b64_tr_b16 a[160:161], v244 offset:8192
    ds_read_b64_tr_b16 a[162:163], v244 offset:8704
    ds_read_b64_tr_b16 a[164:165], v245 offset:8192
    s_waitcnt lgkmcnt(0)
    s_cmp_eq_u32 s94, s65
    s_cbranch_scc1 L_counted_6
    s_mov_b32 s43, 200000
L_cnt_5:
    s_load_dword s94, s[16:17], s59 glc
    s_waitcnt lgkmcnt(0)
    s_cmp_eq_u32 s94, s65
    s_cbranch_scc1 L_counted_6
    s_sub_u32 s43, s43, 1
    s_cbranch_scc0 L_cnt_5
L_counted_6:
    buffer_load_dwordx4 v[128:131], v56, s[16:19], s45 offen offset:0 sc1
    ds_read_b64_tr_b16 a[166:167], v245 offset:8704
    ds_read_b64_tr_b16 a[168:169], v246 offset:8192
    ds_read_b64_tr_b16 a[170:171], v246 offset:8704
    ds_read_b64_tr_b16 a[172:173], v247 offset:8192
    buffer_load_dwordx4 v[132:135], v56, s[16:19], s45 offen offset:1024 sc1
    ds_read_b64_tr_b16 a[174:175], v247 offset:8704
    s_waitcnt vmcnt(10)
    ds_read_b64_tr_b16 a[176:177], v244 offset:12288
    ds_read_b64_tr_b16 a[178:179], v244 offset:12800
    ds_read_b64_tr_b16 a[180:181], v245 offset:12288
    buffer_load_dwordx4 v[136:139], v56, s[16:19], s45 offen offset:2048 sc1
    ds_read_b64_tr_b16 a[182:183], v245 offset:12800
    ds_read_b64_tr_b16 a[184:185], v246 offset:12288
    ds_read_b64_tr_b16 a[186:187], v246 offset:12800
    ds_read_b64_tr_b16 a[188:189], v247 offset:12288
    buffer_load_dwordx4 v[140:143], v56, s[16:19], s45 offen offset:3072 sc1
    s_add_u32 s45, s45, 4096
    s_cmp_eq_u32 s45, 28672
    s_cselect_b32 s45, 0, s45
    ds_read_b64_tr_b16 a[190:191], v247 offset:12800
    s_waitcnt vmcnt(8)
    ds_read_b64_tr_b16 a[192:193], v244 offset:16384
    ds_read_b64_tr_b16 a[194:195], v244 offset:16896
    ds_read_b64_tr_b16 a[196:197], v245 offset:16384
    buffer_load_dwordx4 v[144:147], v56, s[16:19], s45 offen offset:0 sc1
    ds_read_b64_tr_b16 a[198:199], v245 offset:16896
    ds_read_b64_tr_b16 a[200:201], v246 offset:16384
    ds_read_b64_tr_b16 a[202:203], v246 offset:16896
    ds_read_b64_tr_b16 a[204:205], v247 offset:16384
    buffer_load_dwordx4 v[148:151], v56, s[16:19], s45 offen offset:1024 sc1
    ds_read_b64_tr_b16 a[206:207], v247 offset:16896
    s_waitcnt vmcnt(6)
    ds_read_b64_tr_b16 a[208:209], v244 offset:20480
    ds_read_b64_tr_b16 a[210:211], v244 offset:20992
    ds_read_b64_tr_b16 a[212:213], v245 offset:20480
    buffer_load_dwordx4 v[152:155], v56, s[16:19], s45 offen offset:2048 sc1
    ds_read_b64_tr_b16 a[214:215], v245 offset:20992
    ds_read_b64_tr_b16 a[216:217], v246 offset:20480
    ds_read_b64_tr_b16 a[218:219], v246 offset:20992
    ds_read_b64_tr_b16 a[220:221], v247 offset:20480
    buffer_load_dwordx4 v[156:159], v56, s[16:19], s45 offen offset:3072 sc1
    s_add_u32 s45, s45, 4096
    s_cmp_eq_u32 s45, 28672
    s_cselect_b32 s45, 0, s45
    ds_read_b64_tr_b16 a[222:223], v247 offset:20992
    buffer_load_dwordx4 v[160:163], v56, s[16:19], s45 offen offset:0 sc1
    buffer_load_dwordx4 v[164:167], v56, s[16:19], s45 offen offset:1024 sc1
    buffer_load_dwordx4 v[168:171], v56, s[16:19], s45 offen offset:2048 sc1
    buffer_load_dwordx4 v[172:175], v56, s[16:19], s45 offen offset:3072 sc1
    s_add_u32 s45, s45, 4096
    s_cmp_eq_u32 s45, 28672
    s_cselect_b32 s45, 0, s45
    buffer_load_dwordx4 v[176:179], v56, s[16:19], s45 offen offset:0 sc1
    buffer_load_dwordx4 v[180:183], v56, s[16:19], s45 offen offset:1024 sc1
    s_waitcnt vmcnt(13)
    v_mfma_f32_16x16x32_bf16 v[64:67], v[128:131], a[0:3], 0
    s_waitcnt vmcnt(12)
    v_mfma_f32_16x16x32_bf16 v[68:71], v[132:135], a[0:3], 0
    v_mfma_f32_16x16x32_bf16 v[72:75], v[128:131], a[4:7], 0
    v_mfma_f32_16x16x32_bf16 v[76:79], v[132:135], a[4:7], 0
    v_mfma_f32_16x16x32_bf16 v[80:83], v[128:131], a[8:11], 0
    v_mfma_f32_16x16x32_bf16 v[84:87], v[132:135], a[8:11], 0
    v_mfma_f32_16x16x32_bf16 v[88:91], v[128:131], a[12:15], 0
    v_mfma_f32_16x16x32_bf16 v[92:95], v[132:135], a[12:15], 0
    s_waitcnt vmcnt(11)
    v_mfma_f32_16x16x32_bf16 v[64:67], v[136:139], a[16:19], v[64:67]
    buffer_load_dwordx4 v[128:131], v56, s[16:19], s45 offen offset:2048 sc1
    buffer_load_dword v34, v62, s[16:19], 0 offen sc1
    s_waitcnt vmcnt(12)
    v_mfma_f32_16x16x32_bf16 v[68:71], v[140:143], a[16:19], v[68:71]
    v_mfma_f32_16x16x32_bf16 v[72:75], v[136:139], a[20:23], v[72:75]
    v_mfma_f32_16x16x32_bf16 v[76:79], v[140:143], a[20:23], v[76:79]
    v_mfma_f32_16x16x32_bf16 v[80:83], v[136:139], a[24:27], v[80:83]
    buffer_load_dwordx4 v[132:135], v56, s[16:19], s45 offen offset:3072 sc1
    s_add_u32 s45, s45, 4096
    s_cmp_eq_u32 s45, 28672
    s_cselect_b32 s45, 0, s45
    v_mfma_f32_16x16x32_bf16 v[84:87], v[140:143], a[24:27], v[84:87]
    v_mfma_f32_16x16x32_bf16 v[88:91], v[136:139], a[28:31], v[88:91]
    v_mfma_f32_16x16x32_bf16 v[92:95], v[140:143], a[28:31], v[92:95]
    s_waitcnt vmcnt(12)
    v_mfma_f32_16x16x32_bf16 v[64:67], v[144:147], a[32:35], v[64:67]
    buffer_load_dwordx4 v[136:139], v56, s[16:19], s45 offen offset:0 sc1
    s_waitcnt vmcnt(12)
    v_mfma_f32_16x16x32_bf16 v[68:71], v[148:151], a[32:35], v[68:71]
    v_mfma_f32_16x16x32_bf16 v[72:75], v[144:147], a[36:39], v[72:75]
    v_mfma_f32_16x16x32_bf16 v[76:79], v[148:151], a[36:39], v[76:79]
    v_mfma_f32_16x16x32_bf16 v[80:83], v[144:147], a[40:43], v[80:83]
    buffer_load_dwordx4 v[140:143], v56, s[16:19], s45 offen offset:1024 sc1
    v_mfma_f32_16x16x32_bf16 v[84:87], v[148:151], a[40:43], v[84:87]
    v_mfma_f32_16x16x32_bf16 v[88:91], v[144:147], a[44:47], v[88:91]
    v_mfma_f32_16x16x32_bf16 v[92:95], v[148:151], a[44:47], v[92:95]
    s_waitcnt vmcnt(12)
    v_mfma_f32_16x16x32_bf16 v[64:67], v[152:155], a[48:51], v[64:67]
    buffer_load_dwordx4 v[144:147], v56, s[16:19], s45 offen offset:2048 sc1
    s_waitcnt vmcnt(12)
    v_mfma_f32_16x16x32_bf16 v[68:71], v[156:159], a[48:51], v[68:71]
    v_mfma_f32_16x16x32_bf16 v[72:75], v[152:155], a[52:55], v[72:75]
    v_mfma_f32_16x16x32_bf16 v[76:79], v[156:159], a[52:55], v[76:79]
    v_mfma_f32_16x16x32_bf16 v[80:83], v[152:155], a[56:59], v[80:83]
    buffer_load_dwordx4 v[148:151], v56, s[16:19], s45 offen offset:3072 sc1
    s_add_u32 s45, s45, 4096
    s_cmp_eq_u32 s45, 28672
    s_cselect_b32 s45, 0, s45
    v_mfma_f32_16x16x32_bf16 v[84:87], v[156:159], a[56:59], v[84:87]
    v_mfma_f32_16x16x32_bf16 v[88:91], v[152:155], a[60:63], v[88:91]
    v_mfma_f32_16x16x32_bf16 v[92:95], v[156:159], a[60:63], v[92:95]
    s_waitcnt vmcnt(12)
    v_mfma_f32_16x16x32_bf16 v[64:67], v[160:163], a[64:67], v[64:67]
    buffer_load_dwordx4 v[152:155], v56, s[16:19], s45 offen offset:0 sc1
    s_waitcnt vmcnt(12)
    v_mfma_f32_16x16x32_bf16 v[68:71], v[164:167], a[64:67], v[68:71]
    v_mfma_f32_16x16x32_bf16 v[72:75], v[160:163], a[68:71], v[72:75]
    v_mfma_f32_16x16x32_bf16 v[76:79], v[164:167], a[68:71], v[76:79]
    v_mfma_f32_16x16x32_bf16 v[80:83], v[160:163], a[72:75], v[80:83]
    buffer_load_dwordx4 v[156:159], v56, s[16:19], s45 offen offset:1024 sc1
    v_mfma_f32_16x16x32_bf16 v[84:87], v[164:167], a[72:75], v[84:87]
    v_mfma_f32_16x16x32_bf16 v[88:91], v[160:163], a[76:79], v[88:91]
    v_mfma_f32_16x16x32_bf16 v[92:95], v[164:167], a[76:79], v[92:95]
    s_waitcnt vmcnt(12)
    v_mfma_f32_16x16x32_bf16 v[64:67], v[168:171], a[80:83], v[64:67]
    buffer_load_dwordx4 v[160:163], v56, s[16:19], s45 offen offset:2048 sc1
    s_waitcnt vmcnt(12)
    v_mfma_f32_16x16x32_bf16 v[68:71], v[172:175], a[80:83], v[68:71]
    v_mfma_f32_16x16x32_bf16 v[72:75], v[168:171], a[84:87], v[72:75]
    v_mfma_f32_16x16x32_bf16 v[76:79], v[172:175], a[84:87], v[76:79]
    v_mfma_f32_16x16x32_bf16 v[80:83], v[168:171], a[88:91], v[80:83]
    buffer_load_dwordx4 v[164:167], v56, s[16:19], s45 offen offset:3072 sc1
    s_add_u32 s45, s45, 4096
    s_cmp_eq_u32 s45, 28672
    s_cselect_b32 s45, 0, s45
    v_mfma_f32_16x16x32_bf16 v[84:87], v[172:175], a[88:91], v[84:87]
    v_mfma_f32_16x16x32_bf16 v[88:91], v[168:171], a[92:95], v[88:91]
    v_mfma_f32_16x16x32_bf16 v[92:95], v[172:175], a[92:95], v[92:95]
    s_waitcnt vmcnt(12)
    v_mfma_f32_16x16x32_bf16 v[64:67], v[176:179], a[96:99], v[64:67]
    buffer_load_dwordx4 v[168:171], v56, s[16:19], s45 offen offset:0 sc1
    s_waitcnt vmcnt(12)
    v_mfma_f32_16x16x32_bf16 v[68:71], v[180:183], a[96:99], v[68:71]
    v_mfma_f32_16x16x32_bf16 v[72:75], v[176:179], a[100:103], v[72:75]
    v_mfma_f32_16x16x32_bf16 v[76:79], v[180:183], a[100:103], v[76:79]
    v_mfma_f32_16x16x32_bf16 v[80:83], v[176:179], a[104:107], v[80:83]
    buffer_load_dwordx4 v[172:175], v56, s[16:19], s45 offen offset:1024 sc1
    v_mfma_f32_16x16x32_bf16 v[84:87], v[180:183], a[104:107], v[84:87]
    v_mfma_f32_16x16x32_bf16 v[88:91], v[176:179], a[108:111], v[88:91]
    v_mfma_f32_16x16x32_bf16 v[92:95], v[180:183], a[108:111], v[92:95]
    s_waitcnt vmcnt(12)
    v_mfma_f32_16x16x32_bf16 v[64:67], v[128:131], a[112:115], v[64:67]
    buffer_load_dwordx4 v[176:179], v56, s[16:19], s45 offen offset:2048 sc1
    s_waitcnt vmcnt(11)
    v_mfma_f32_16x16x32_bf16 v[68:71], v[132:135], a[112:115], v[68:71]
    v_mfma_f32_16x16x32_bf16 v[72:75], v[128:131], a[116:119], v[72:75]
    v_mfma_f32_16x16x32_bf16 v[76:79], v[132:135], a[116:119], v[76:79]
    v_mfma_f32_16x16x32_bf16 v[80:83], v[128:131], a[120:123], v[80:83]
    buffer_load_dwordx4 v[180:183], v56, s[16:19], s45 offen offset:3072 sc1
    s_add_u32 s45, s45, 4096
    s_cmp_eq_u32 s45, 28672
    s_cselect_b32 s45, 0, s45
    v_mfma_f32_16x16x32_bf16 v[84:87], v[132:135], a[120:123], v[84:87]
    v_mfma_f32_16x16x32_bf16 v[88:91], v[128:131], a[124:127], v[88:91]
    v_mfma_f32_16x16x32_bf16 v[92:95], v[132:135], a[124:127], v[92:95]
    s_waitcnt vmcnt(11)
    v_mfma_f32_16x16x32_bf16 v[64:67], v[136:139], a[128:131], v[64:67]
    buffer_load_dwordx4 v[128:131], v57, s[16:19], s45 offen offset:0 sc1
    v_cmp_ne_u32 vcc, v34, v2
    s_cbranch_vccz L_fast_7
    s_mov_b32 s43, 200000
L_poll_8:
    buffer_load_dword v34, v62, s[16:19], 0 offen sc1
    s_waitcnt vmcnt(0)
    v_cmp_ne_u32 vcc, v34, v2
    s_cbranch_vccz L_polled_9
    s_sub_u32 s43, s43, 1
    s_cbranch_scc0 L_poll_8
L_polled_9:
L_fast_7:
    v_lshrrev_b32 v217, 8, v36
    v_and_b32 v217, 0x1ffc, v217
    v_sub_u32 v218, 8192, v217
    v_and_b32 v218, 0x1ffc, v218
    buffer_load_dword v217, v217, s[16:19], s89 offen sc1
    buffer_load_dword v218, v218, s[16:19], s89 offen sc1
    buffer_load_dword v212, v58, s[16:19], 0 offen sc1
    buffer_load_dword v213, v60, s[16:19], s84 offen sc1
    buffer_load_dword v214, v60, s[16:19], s85 offen sc1
    buffer_load_dword v215, v60, s[16:19], s86 offen sc1
    buffer_load_dword v216, v60, s[16:19], s87 offen sc1
    buffer_load_dword v224, v59, s[16:19], 0 offen sc1
    buffer_load_dword v225, v61, s[16:19], s84 offen sc1
    buffer_load_dword v226, v61, s[16:19], s85 offen sc1
    buffer_load_dword v227, v61, s[16:19], s86 offen sc1
    buffer_load_dword v228, v61, s[16:19], s87 offen sc1
    s_waitcnt vmcnt(23)
    v_mfma_f32_16x16x32_bf16 v[68:71], v[140:143], a[128:131], v[68:71]
    v_mfma_f32_16x16x32_bf16 v[72:75], v[136:139], a[132:135], v[72:75]
    v_mfma_f32_16x16x32_bf16 v[76:79], v[140:143], a[132:135], v[76:79]
    v_mfma_f32_16x16x32_bf16 v[80:83], v[136:139], a[136:139], v[80:83]
    buffer_load_dwordx4 v[132:135], v57, s[16:19], s45 offen offset:1024 sc1
    v_mfma_f32_16x16x32_bf16 v[84:87], v[140:143], a[136:139], v[84:87]
    v_mfma_f32_16x16x32_bf16 v[88:91], v[136:139], a[140:143], v[88:91]
    v_mfma_f32_16x16x32_bf16 v[92:95], v[140:143], a[140:143], v[92:95]
    s_waitcnt vmcnt(23)
    v_mfma_f32_16x16x32_bf16 v[64:67], v[144:147], a[144:147], v[64:67]
    buffer_load_dwordx4 v[136:139], v57, s[16:19], s45 offen offset:2048 sc1
    s_waitcnt vmcnt(23)
    v_mfma_f32_16x16x32_bf16 v[68:71], v[148:151], a[144:147], v[68:71]
    v_mfma_f32_16x16x32_bf16 v[72:75], v[144:147], a[148:151], v[72:75]
    v_mfma_f32_16x16x32_bf16 v[76:79], v[148:151], a[148:151], v[76:79]
    v_mfma_f32_16x16x32_bf16 v[80:83], v[144:147], a[152:155], v[80:83]
    buffer_load_dwordx4 v[140:143], v57, s[16:19], s45 offen offset:3072 sc1
    s_add_u32 s45, s45, 4096
    s_cmp_eq_u32 s45, 28672
    s_cselect_b32 s45, 0, s45
    v_mfma_f32_16x16x32_bf16 v[84:87], v[148:151], a[152:155], v[84:87]
    v_mfma_f32_16x16x32_bf16 v[88:91], v[144:147], a[156:159], v[88:91]
    v_mfma_f32_16x16x32_bf16 v[92:95], v[148:151], a[156:159], v[92:95]
    s_waitcnt vmcnt(23)
    v_mfma_f32_16x16x32_bf16 v[64:67], v[152:155], a[160:163], v[64:67]
    buffer_load_dwordx4 v[144:147], v57, s[16:19], s45 offen offset:0 sc1
    s_waitcnt vmcnt(23)
    v_mfma_f32_16x16x32_bf16 v[68:71], v[156:159], a[160:163], v[68:71]
    s_waitcnt lgkmcnt(15)
    v_mfma_f32_16x16x32_bf16 v[72:75], v[152:155], a[164:167], v[72:75]
    v_mfma_f32_16x16x32_bf16 v[76:79], v[156:159], a[164:167], v[76:79]
    v_mfma_f32_16x16x32_bf16 v[80:83], v[152:155], a[168:171], v[80:83]
    buffer_load_dwordx4 v[148:151], v57, s[16:19], s45 offen offset:1024 sc1
    v_mfma_f32_16x16x32_bf16 v[84:87], v[156:159], a[168:171], v[84:87]
    v_mfma_f32_16x16x32_bf16 v[88:91], v[152:155], a[172:175], v[88:91]
    v_mfma_f32_16x16x32_bf16 v[92:95], v[156:159], a[172:175], v[92:95]
    s_waitcnt vmcnt(23)
    v_mfma_f32_16x16x32_bf16 v[64:67], v[160:163], a[176:179], v[64:67]
    buffer_load_dwordx4 v[152:155], v57, s[16:19], s45 offen offset:2048 sc1
    s_waitcnt vmcnt(23)
    v_mfma_f32_16x16x32_bf16 v[68:71], v[164:167], a[176:179], v[68:71]
    v_mfma_f32_16x16x32_bf16 v[72:75], v[160:163], a[180:183], v[72:75]
    v_mfma_f32_16x16x32_bf16 v[76:79], v[164:167], a[180:183], v[76:79]
    v_mfma_f32_16x16x32_bf16 v[80:83], v[160:163], a[184:187], v[80:83]
    buffer_load_dwordx4 v[156:159], v57, s[16:19], s45 offen offset:3072 sc1
    s_add_u32 s45, s45, 4096
    s_cmp_eq_u32 s45, 28672
    s_cselect_b32 s45, 0, s45
    v_mfma_f32_16x16x32_bf16 v[84:87], v[164:167], a[184:187], v[84:87]
    v_mfma_f32_16x16x32_bf16 v[88:91], v[160:163], a[188:191], v[88:91]
    v_mfma_f32_16x16x32_bf16 v[92:95], v[164:167], a[188:191], v[92:95]
    s_waitcnt vmcnt(23) lgkmcnt(14)
    v_mfma_f32_16x16x32_bf16 v[64:67], v[168:171], a[192:195], v[64:67]
    buffer_load_dwordx4 v[160:163], v57, s[16:19], s45 offen offset:0 sc1
    s_waitcnt vmcnt(23)
    v_mfma_f32_16x16x32_bf16 v[68:71], v[172:175], a[192:195], v[68:71]
    s_waitcnt lgkmcnt(12)
    v_mfma_f32_16x16x32_bf16 v[72:75], v[168:171], a[196:199], v[72:75]
    v_mfma_f32_16x16x32_bf16 v[76:79], v[172:175], a[196:199], v[76:79]
    s_waitcnt lgkmcnt(10)
    v_mfma_f32_16x16x32_bf16 v[80:83], v[168:171], a[200:203], v[80:83]
    buffer_load_dwordx4 v[164:167], v57, s[16:19], s45 offen offset:1024 sc1
    v_mfma_f32_16x16x32_bf16 v[84:87], v[172:175], a[200:203], v[84:87]
    s_waitcnt lgkmcnt(8)
    v_mfma_f32_16x16x32_bf16 v[88:91], v[168:171], a[204:207], v[88:91]
    v_mfma_f32_16x16x32_bf16 v[92:95], v[172:175], a[204:207], v[92:95]
    s_waitcnt vmcnt(23) lgkmcnt(6)
    v_mfma_f32_16x16x32_bf16 v[64:67], v[176:179], a[208:211], v[64:67]
    buffer_load_dwordx4 v[168:171], v57, s[16:19], s45 offen offset:2048 sc1
    s_waitcnt vmcnt(18)
    v_bfi_b32 v212, s88, v212, v213
    s_waitcnt vmcnt(17)
    v_bfi_b32 v213, s88, v213, v214
    s_waitcnt vmcnt(16)
    v_bfi_b32 v214, s88, v214, v215
    s_waitcnt vmcnt(15)
    v_bfi_b32 v215, s88, v215, v216
    v_lshlrev_b32 v192, 16, v212
    v_and_b32 v193, 0xffff0000, v212
    v_mfma_f32_16x16x32_bf16 v[68:71], v[180:183], a[208:211], v[68:71]
    v_lshlrev_b32 v194, 16, v213
    v_and_b32 v195, 0xffff0000, v213
    s_waitcnt lgkmcnt(4)
    v_mfma_f32_16x16x32_bf16 v[72:75], v[176:179], a[212:215], v[72:75]
    v_lshlrev_b32 v196, 16, v214
    v_and_b32 v197, 0xffff0000, v214
    v_mfma_f32_16x16x32_bf16 v[76:79], v[180:183], a[212:215], v[76:79]
    v_lshlrev_b32 v198, 16, v215
    v_and_b32 v199, 0xffff0000, v215
    s_waitcnt lgkmcnt(2)
    v_mfma_f32_16x16x32_bf16 v[80:83], v[176:179], a[216:219], v[80:83]
    buffer_load_dwordx4 v[172:175], v57, s[16:19], s45 offen offset:3072 sc1
    s_add_u32 s45, s45, 4096
    s_cmp_eq_u32 s45, 28672
    s_cselect_b32 s45, 0, s45
    v_lshlrev_b32 v200, 16, v208
    v_and_b32 v201, 0xffff0000, v208
    v_mfma_f32_16x16x32_bf16 v[84:87], v[180:183], a[216:219], v[84:87]
    v_lshlrev_b32 v202, 16, v209
    v_and_b32 v203, 0xffff0000, v209
    s_waitcnt lgkmcnt(0)
    v_mfma_f32_16x16x32_bf16 v[88:91], v[176:179], a[220:223], v[88:91]
    v_lshlrev_b32 v204, 16, v210
    v_and_b32 v205, 0xffff0000, v210
    v_mfma_f32_16x16x32_bf16 v[92:95], v[180:183], a[220:223], v[92:95]
    v_lshlrev_b32 v206, 16, v211
    v_and_b32 v207, 0xffff0000, v211
    v_mfma_f32_16x16x32_bf16 v[96:99], v[128:131], a[0:3], 0
    buffer_load_dwordx4 v[176:179], v57, s[16:19], s45 offen offset:0 sc1
    v_lshlrev_b32 v217, s3, v217
    v_lshlrev_b32 v218, s3, v218
    s_waitcnt vmcnt(11)
    v_mfma_f32_16x16x32_bf16 v[100:103], v[132:135], a[0:3], 0
    v_add_f32 v217, v217, v218
    v_mul_f32 v217, 0.5, v217
    v_mfma_f32_16x16x32_bf16 v[104:107], v[128:131], a[4:7], 0
    v_cvt_pk_bf16_f32 v217, 0, v217
    v_cndmask_b32 v192, v192, v217, s[90:91]
    v_mfma_f32_16x16x32_bf16 v[108:111], v[132:135], a[4:7], 0
    v_bfi_b32 v224, s88, v224, v225
    v_bfi_b32 v225, s88, v225, v226
    v_mfma_f32_16x16x32_bf16 v[112:115], v[128:131], a[8:11], 0
    buffer_load_dwordx4 v[180:183], v57, s[16:19], s45 offen offset:1024 sc1
    v_bfi_b32 v226, s88, v226, v227
    v_bfi_b32 v227, s88, v227, v228
    v_mfma_f32_16x16x32_bf16 v[116:119], v[132:135], a[8:11], 0
    v_lshlrev_b32 v40, 16, v224
    v_and_b32 v41, 0xffff0000, v224
    v_mfma_f32_16x16x32_bf16 v[120:123], v[128:131], a[12:15], 0
    v_lshlrev_b32 v42, 16, v225
    v_and_b32 v43, 0xffff0000, v225
    v_mfma_f32_16x16x32_bf16 v[124:127], v[132:135], a[12:15], 0
    v_lshlrev_b32 v44, 16, v226
    v_and_b32 v45, 0xffff0000, v226
    s_waitcnt vmcnt(11)
    v_mfma_f32_16x16x32_bf16 v[96:99], v[136:139], a[16:19], v[96:99]
    buffer_load_dwordx4 v[128:131], v57, s[16:19], s45 offen offset:2048 sc1
    v_lshlrev_b32 v46, 16, v227
    v_and_b32 v47, 0xffff0000, v227
    s_waitcnt vmcnt(11)
    v_mfma_f32_16x16x32_bf16 v[100:103], v[140:143], a[16:19], v[100:103]
    v_lshlrev_b32 v48, 16, v220
    v_and_b32 v49, 0xffff0000, v220
    v_mfma_f32_16x16x32_bf16 v[104:107], v[136:139], a[20:23], v[104:107]
    v_lshlrev_b32 v50, 16, v221
    v_and_b32 v51, 0xffff0000, v221
    v_mfma_f32_16x16x32_bf16 v[108:111], v[140:143], a[20:23], v[108:111]
    v_lshlrev_b32 v52, 16, v222
    v_and_b32 v53, 0xffff0000, v222
    v_mfma_f32_16x16x32_bf16 v[112:115], v[136:139], a[24:27], v[112:115]
    buffer_load_dwordx4 v[132:135], v57, s[16:19], s45 offen offset:3072 sc1
    s_add_u32 s45, s45, 4096
    s_cmp_eq_u32 s45, 28672
    s_cselect_b32 s45, 0, s45
    v_lshlrev_b32 v54, 16, v223
    v_and_b32 v55, 0xffff0000, v223
    v_mfma_f32_16x16x32_bf16 v[116:119], v[140:143], a[24:27], v[116:119]
    v_mfma_f32_16x16x32_bf16 v[120:123], v[136:139], a[28:31], v[120:123]
    v_mfma_f32_16x16x32_bf16 v[124:127], v[140:143], a[28:31], v[124:127]
    ds_write_b128 v20, v[72:75] offset:0
    s_waitcnt vmcnt(11)
    v_mfma_f32_16x16x32_bf16 v[96:99], v[144:147], a[32:35], v[96:99]
    buffer_load_dwordx4 v[136:139], v57, s[16:19], s45 offen offset:0 sc1
    s_waitcnt vmcnt(11)
    v_mfma_f32_16x16x32_bf16 v[100:103], v[148:151], a[32:35], v[100:103]
    v_mfma_f32_16x16x32_bf16 v[104:107], v[144:147], a[36:39], v[104:107]
    ds_write_b128 v20, v[76:79] offset:1024
    v_mfma_f32_16x16x32_bf16 v[108:111], v[148:151], a[36:39], v[108:111]
    v_mfma_f32_16x16x32_bf16 v[112:115], v[144:147], a[40:43], v[112:115]
    buffer_load_dwordx4 v[140:143], v57, s[16:19], s45 offen offset:1024 sc1
    v_mfma_f32_16x16x32_bf16 v[116:119], v[148:151], a[40:43], v[116:119]
    ds_write_b128 v21, v[80:83] offset:0
    v_mfma_f32_16x16x32_bf16 v[120:123], v[144:147], a[44:47], v[120:123]
    v_mfma_f32_16x16x32_bf16 v[124:127], v[148:151], a[44:47], v[124:127]
    s_waitcnt vmcnt(11)
    v_mfma_f32_16x16x32_bf16 v[96:99], v[152:155], a[48:51], v[96:99]
    buffer_load_dwordx4 v[144:147], v57, s[16:19], s45 offen offset:2048 sc1
    ds_write_b128 v21, v[84:87] offset:1024
    s_waitcnt vmcnt(11)
    v_mfma_f32_16x16x32_bf16 v[100:103], v[156:159], a[48:51], v[100:103]
    v_mfma_f32_16x16x32_bf16 v[104:107], v[152:155], a[52:55], v[104:107]
    v_mfma_f32_16x16x32_bf16 v[108:111], v[156:159], a[52:55], v[108:111]
    ds_write_b128 v22, v[88:91] offset:0
    v_mfma_f32_16x16x32_bf16 v[112:115], v[152:155], a[56:59], v[112:115]
    buffer_load_dwordx4 v[148:151], v57, s[16:19], s45 offen offset:3072 sc1
    s_add_u32 s45, s45, 4096
    s_cmp_eq_u32 s45, 28672
    s_cselect_b32 s45, 0, s45
    v_mfma_f32_16x16x32_bf16 v[116:119], v[156:159], a[56:59], v[116:119]
    v_mfma_f32_16x16x32_bf16 v[120:123], v[152:155], a[60:63], v[120:123]
    ds_write_b128 v22, v[92:95] offset:1024
    v_mfma_f32_16x16x32_bf16 v[124:127], v[156:159], a[60:63], v[124:127]
    s_waitcnt vmcnt(11)
    v_mfma_f32_16x16x32_bf16 v[96:99], v[160:163], a[64:67], v[96:99]
    buffer_load_dwordx4 v[152:155], v57, s[16:19], s45 offen offset:0 sc1
    s_waitcnt vmcnt(11)
    v_mfma_f32_16x16x32_bf16 v[100:103], v[164:167], a[64:67], v[100:103]
    s_waitcnt lgkmcnt(0)
    v_mfma_f32_16x16x32_bf16 v[104:107], v[160:163], a[68:71], v[104:107]
    v_mfma_f32_16x16x32_bf16 v[108:111], v[164:167], a[68:71], v[108:111]
    s_barrier
    v_mfma_f32_16x16x32_bf16 v[112:115], v[160:163], a[72:75], v[112:115]
    buffer_load_dwordx4 v[156:159], v57, s[16:19], s45 offen offset:1024 sc1
    ds_read_b128 v[72:75], v23 offset:0
    v_mfma_f32_16x16x32_bf16 v[116:119], v[164:167], a[72:75], v[116:119]
    v_mfma_f32_16x16x32_bf16 v[120:123], v[160:163], a[76:79], v[120:123]
    ds_read_b128 v[76:79], v23 offset:1024
    v_mfma_f32_16x16x32_bf16 v[124:127], v[164:167], a[76:79], v[124:127]
    ds_read_b128 v[80:83], v23 offset:2048
    s_waitcnt vmcnt(11)
    v_mfma_f32_16x16x32_bf16 v[96:99], v[168:171], a[80:83], v[96:99]
    buffer_load_dwordx4 v[160:163], v57, s[16:19], s45 offen offset:2048 sc1
    s_waitcnt vmcnt(11)
    v_mfma_f32_16x16x32_bf16 v[100:103], v[172:175], a[80:83], v[100:103]
    ds_read_b128 v[84:87], v23 offset:3072
    v_mfma_f32_16x16x32_bf16 v[104:107], v[168:171], a[84:87], v[104:107]
    ds_read_b128 v[88:91], v23 offset:4096
    v_mfma_f32_16x16x32_bf16 v[108:111], v[172:175], a[84:87], v[108:111]
    v_mfma_f32_16x16x32_bf16 v[112:115], v[168:171], a[88:91], v[112:115]
    buffer_load_dwordx4 v[164:167], v57, s[16:19], s45 offen offset:3072 sc1
    s_add_u32 s45, s45, 4096
    s_cmp_eq_u32 s45, 28672
    s_cselect_b32 s45, 0, s45
    ds_read_b128 v[92:95], v23 offset:5120
    v_mfma_f32_16x16x32_bf16 v[116:119], v[172:175], a[88:91], v[116:119]
    v_mfma_f32_16x16x32_bf16 v[120:123], v[168:171], a[92:95], v[120:123]
    v_mfma_f32_16x16x32_bf16 v[124:127], v[172:175], a[92:95], v[124:127]
    s_waitcnt vmcnt(11)
    v_mfma_f32_16x16x32_bf16 v[96:99], v[176:179], a[96:99], v[96:99]
    buffer_load_dwordx4 v[168:171], v57, s[16:19], s45 offen offset:0 sc1
    s_waitcnt vmcnt(11)
    v_mfma_f32_16x16x32_bf16 v[100:103], v[180:183], a[96:99], v[100:103]
    v_mfma_f32_16x16x32_bf16 v[104:107], v[176:179], a[100:103], v[104:107]
    v_mfma_f32_16x16x32_bf16 v[108:111], v[180:183], a[100:103], v[108:111]
    s_waitcnt lgkmcnt(5)
    v_add_f32 v64, v64, v72
    v_add_f32 v65, v65, v73
    v_mfma_f32_16x16x32_bf16 v[112:115], v[176:179], a[104:107], v[112:115]
    buffer_load_dwordx4 v[172:175], v57, s[16:19], s45 offen offset:1024 sc1
    v_add_f32 v66, v66, v74
    v_add_f32 v67, v67, v75
    v_mfma_f32_16x16x32_bf16 v[116:119], v[180:183], a[104:107], v[116:119]
    s_waitcnt lgkmcnt(4)
    v_add_f32 v68, v68, v76
    v_add_f32 v69, v69, v77
    v_mfma_f32_16x16x32_bf16 v[120:123], v[176:179], a[108:111], v[120:123]
    v_add_f32 v70, v70, v78
    v_add_f32 v71, v71, v79
    v_mfma_f32_16x16x32_bf16 v[124:127], v[180:183], a[108:111], v[124:127]
    s_waitcnt lgkmcnt(1)
    v_add_f32 v80, v80, v88
    v_add_f32 v81, v81, v89
    s_waitcnt vmcnt(11)
    v_mfma_f32_16x16x32_bf16 v[96:99], v[128:131], a[112:115], v[96:99]
    buffer_load_dwordx4 v[176:179], v57, s[16:19], s45 offen offset:2048 sc1
    v_add_f32 v82, v82, v90
    v_add_f32 v83, v83, v91
    s_waitcnt vmcnt(11)
    v_mfma_f32_16x16x32_bf16 v[100:103], v[132:135], a[112:115], v[100:103]
    s_waitcnt lgkmcnt(0)
    v_add_f32 v84, v84, v92
    v_add_f32 v85, v85, v93
    v_mfma_f32_16x16x32_bf16 v[104:107], v[128:131], a[116:119], v[104:107]
    v_add_f32 v86, v86, v94
    v_add_f32 v87, v87, v95
    v_mfma_f32_16x16x32_bf16 v[108:111], v[132:135], a[116:119], v[108:111]
    v_add_f32 v64, v64, v80
    v_add_f32 v65, v65, v81
    v_mfma_f32_16x16x32_bf16 v[112:115], v[128:131], a[120:123], v[112:115]
    buffer_load_dwordx4 v[180:183], v57, s[16:19], s45 offen offset:3072 sc1
    s_add_u32 s45, s45, 4096
    s_cmp_eq_u32 s45, 28672
    s_cselect_b32 s45, 0, s45
    v_add_f32 v66, v66, v82
    v_add_f32 v67, v67, v83
    v_mfma_f32_16x16x32_bf16 v[116:119], v[132:135], a[120:123], v[116:119]
    v_add_f32 v68, v68, v84
    v_add_f32 v69, v69, v85
    v_mfma_f32_16x16x32_bf16 v[120:123], v[128:131], a[124:127], v[120:123]
    v_add_f32 v70, v70, v86
    v_add_f32 v71, v71, v87
    v_mfma_f32_16x16x32_bf16 v[124:127], v[132:135], a[124:127], v[124:127]
    s_waitcnt vmcnt(11)
    v_mfma_f32_16x16x32_bf16 v[104:107], v[136:139], a[132:135], v[104:107]
    s_barrier
    v_cvt_pk_bf16_f32 v64, 0, v64
    v_cvt_pk_bf16_f32 v65, 0, v65
    s_waitcnt vmcnt(10)
    v_mfma_f32_16x16x32_bf16 v[108:111], v[140:143], a[132:135], v[108:111]
    v_cvt_pk_bf16_f32 v66, 0, v66
    v_cvt_pk_bf16_f32 v67, 0, v67
    v_cvt_pk_bf16_f32 v68, 0, v68
    v_mfma_f32_16x16x32_bf16 v[112:115], v[136:139], a[136:139], v[112:115]
    v_cvt_pk_bf16_f32 v69, 0, v69
    v_cvt_pk_bf16_f32 v70, 0, v70
    v_cvt_pk_bf16_f32 v71, 0, v71
    v_mfma_f32_16x16x32_bf16 v[116:119], v[140:143], a[136:139], v[116:119]
    v_add_f32 v64, v64, v37
    v_add_f32 v65, v65, v37
    v_add_f32 v66, v66, v37
    v_mfma_f32_16x16x32_bf16 v[120:123], v[136:139], a[140:143], v[120:123]
    v_add_f32 v67, v67, v37
    v_add_f32 v68, v68, v37
    v_add_f32 v69, v69, v37
    v_mfma_f32_16x16x32_bf16 v[124:127], v[140:143], a[140:143], v[124:127]
    v_add_f32 v70, v70, v37
    v_add_f32 v71, v71, v37
    v_cvt_pk_bf16_f32 v64, 0, v64
    s_waitcnt vmcnt(9)
    v_mfma_f32_16x16x32_bf16 v[104:107], v[144:147], a[148:151], v[104:107]
    v_cvt_pk_bf16_f32 v65, 0, v65
    v_cvt_pk_bf16_f32 v66, 0, v66
    v_cvt_pk_bf16_f32 v67, 0, v67
    s_waitcnt vmcnt(8)
    v_mfma_f32_16x16x32_bf16 v[108:111], v[148:151], a[148:151], v[108:111]
    v_cvt_pk_bf16_f32 v68, 0, v68
    v_cvt_pk_bf16_f32 v69, 0, v69
    v_cvt_pk_bf16_f32 v70, 0, v70
    v_mfma_f32_16x16x32_bf16 v[112:115], v[144:147], a[152:155], v[112:115]
    v_cvt_pk_bf16_f32 v71, 0, v71
    v_mul_f32 v72, 0xbfb8aa3b, v64
    v_mul_f32 v73, 0xbfb8aa3b, v65
    v_mfma_f32_16x16x32_bf16 v[116:119], v[148:151], a[152:155], v[116:119]
    v_mul_f32 v74, 0xbfb8aa3b, v66
    v_mul_f32 v75, 0xbfb8aa3b, v67
    v_mul_f32 v76, 0xbfb8aa3b, v68
    v_mfma_f32_16x16x32_bf16 v[120:123], v[144:147], a[156:159], v[120:123]
    v_mul_f32 v77, 0xbfb8aa3b, v69
    v_mul_f32 v78, 0xbfb8aa3b, v70
    v_mul_f32 v79, 0xbfb8aa3b, v71
    v_mfma_f32_16x16x32_bf16 v[124:127], v[148:151], a[156:159], v[124:127]
    v_exp_f32 v72, v72
    s_waitcnt vmcnt(7)
    v_mfma_f32_16x16x32_bf16 v[104:107], v[152:155], a[164:167], v[104:107]
    v_exp_f32 v73, v73
    v_exp_f32 v74, v74
    s_waitcnt vmcnt(6)
    v_mfma_f32_16x16x32_bf16 v[108:111], v[156:159], a[164:167], v[108:111]
    v_exp_f32 v75, v75
    v_mfma_f32_16x16x32_bf16 v[112:115], v[152:155], a[168:171], v[112:115]
    v_exp_f32 v76, v76
    v_exp_f32 v77, v77
    v_mfma_f32_16x16x32_bf16 v[116:119], v[156:159], a[168:171], v[116:119]
    v_exp_f32 v78, v78
    v_mfma_f32_16x16x32_bf16 v[120:123], v[152:155], a[172:175], v[120:123]
    v_exp_f32 v79, v79
    v_add_f32 v72, 1.0, v72
    v_add_f32 v73, 1.0, v73
    v_mfma_f32_16x16x32_bf16 v[124:127], v[156:159], a[172:175], v[124:127]
    v_add_f32 v74, 1.0, v74
    v_add_f32 v75, 1.0, v75
    v_add_f32 v76, 1.0, v76
    s_waitcnt vmcnt(5)
    v_mfma_f32_16x16x32_bf16 v[104:107], v[160:163], a[180:183], v[104:107]
    v_add_f32 v77, 1.0, v77
    v_add_f32 v78, 1.0, v78
    v_add_f32 v79, 1.0, v79
    s_waitcnt vmcnt(4)
    v_mfma_f32_16x16x32_bf16 v[108:111], v[164:167], a[180:183], v[108:111]
    v_rcp_f32 v72, v72
    v_mfma_f32_16x16x32_bf16 v[112:115], v[160:163], a[184:187], v[112:115]
    v_rcp_f32 v73, v73
    v_rcp_f32 v74, v74
    v_mfma_f32_16x16x32_bf16 v[116:119], v[164:167], a[184:187], v[116:119]
    v_rcp_f32 v75, v75
    v_mfma_f32_16x16x32_bf16 v[120:123], v[160:163], a[188:191], v[120:123]
    v_rcp_f32 v76, v76
    v_rcp_f32 v77, v77
    v_mfma_f32_16x16x32_bf16 v[124:127], v[164:167], a[188:191], v[124:127]
    v_rcp_f32 v78, v78
    s_waitcnt vmcnt(3)
    v_mfma_f32_16x16x32_bf16 v[104:107], v[168:171], a[196:199], v[104:107]
    v_rcp_f32 v79, v79
    v_mul_f32 v64, v64, v72
    v_mul_f32 v65, v65, v73
    s_waitcnt vmcnt(2)
    v_mfma_f32_16x16x32_bf16 v[108:111], v[172:175], a[196:199], v[108:111]
    v_mul_f32 v66, v66, v74
    v_mul_f32 v67, v67, v75
    v_mul_f32 v68, v68, v76
    v_mfma_f32_16x16x32_bf16 v[112:115], v[168:171], a[200:203], v[112:115]
    v_mul_f32 v69, v69, v77
    v_mul_f32 v70, v70, v78
    v_mul_f32 v71, v71, v79
    v_mfma_f32_16x16x32_bf16 v[116:119], v[172:175], a[200:203], v[116:119]
    v_cvt_pk_bf16_f32 v64, 0, v64
    v_cvt_pk_bf16_f32 v65, 0, v65
    v_cvt_pk_bf16_f32 v66, 0, v66
    v_mfma_f32_16x16x32_bf16 v[120:123], v[168:171], a[204:207], v[120:123]
    v_cvt_pk_bf16_f32 v67, 0, v67
    v_cvt_pk_bf16_f32 v68, 0, v68
    v_cvt_pk_bf16_f32 v69, 0, v69
    v_mfma_f32_16x16x32_bf16 v[124:127], v[172:175], a[204:207], v[124:127]
    v_cvt_pk_bf16_f32 v70, 0, v70
    v_cvt_pk_bf16_f32 v71, 0, v71
    v_mul_f32 v64, v64, v192
    s_waitcnt vmcnt(1)
    v_mfma_f32_16x16x32_bf16 v[104:107], v[176:179], a[212:215], v[104:107]
    v_mul_f32 v65, v65, v193
    v_mul_f32 v66, v66, v194
    v_mul_f32 v67, v67, v195
    s_waitcnt vmcnt(0)
    v_mfma_f32_16x16x32_bf16 v[108:111], v[180:183], a[212:215], v[108:111]
    v_mul_f32 v68, v68, v196
    v_mul_f32 v69, v69, v197
    v_mul_f32 v70, v70, v198
    v_mfma_f32_16x16x32_bf16 v[112:115], v[176:179], a[216:219], v[112:115]
    v_mul_f32 v71, v71, v199
    v_cvt_pk_bf16_f32 v64, 0, v64
    v_cvt_pk_bf16_f32 v65, 0, v65
    v_mfma_f32_16x16x32_bf16 v[116:119], v[180:183], a[216:219], v[116:119]
    v_cvt_pk_bf16_f32 v66, 0, v66
    v_cvt_pk_bf16_f32 v67, 0, v67
    v_cvt_pk_bf16_f32 v68, 0, v68
    v_mfma_f32_16x16x32_bf16 v[120:123], v[176:179], a[220:223], v[120:123]
    v_cvt_pk_bf16_f32 v69, 0, v69
    v_cvt_pk_bf16_f32 v70, 0, v70
    v_cvt_pk_bf16_f32 v71, 0, v71
    v_mfma_f32_16x16x32_bf16 v[124:127], v[180:183], a[220:223], v[124:127]
    v_add_f32 v64, v64, v200
    v_add_f32 v65, v65, v201
    v_add_f32 v66, v66, v202
    v_mfma_f32_16x16x32_bf16 v[96:99], v[136:139], a[128:131], v[96:99]
    v_mfma_f32_16x16x32_bf16 v[100:103], v[140:143], a[128:131], v[100:103]
    ds_write_b128 v20, v[104:107] offset:0
    v_mfma_f32_16x16x32_bf16 v[96:99], v[144:147], a[144:147], v[96:99]
    v_mfma_f32_16x16x32_bf16 v[100:103], v[148:151], a[144:147], v[100:103]
    ds_write_b128 v20, v[108:111] offset:1024
    v_mfma_f32_16x16x32_bf16 v[96:99], v[152:155], a[160:163], v[96:99]
    v_mfma_f32_16x16x32_bf16 v[100:103], v[156:159], a[160:163], v[100:103]
    ds_write_b128 v21, v[112:115] offset:0
    v_mfma_f32_16x16x32_bf16 v[96:99], v[160:163], a[176:179], v[96:99]
    v_mfma_f32_16x16x32_bf16 v[100:103], v[164:167], a[176:179], v[100:103]
    ds_write_b128 v21, v[116:119] offset:1024
    v_mfma_f32_16x16x32_bf16 v[96:99], v[168:171], a[192:195], v[96:99]
    v_mfma_f32_16x16x32_bf16 v[100:103], v[172:175], a[192:195], v[100:103]
    ds_write_b128 v22, v[120:123] offset:0
    v_mfma_f32_16x16x32_bf16 v[96:99], v[176:179], a[208:211], v[96:99]
    v_mfma_f32_16x16x32_bf16 v[100:103], v[180:183], a[208:211], v[100:103]
    ds_write_b128 v22, v[124:127] offset:1024
    v_add_f32 v67, v67, v203
    v_add_f32 v68, v68, v204
    v_add_f32 v69, v69, v205
    v_add_f32 v70, v70, v206
    v_add_f32 v71, v71, v207
    v_cvt_pk_bf16_f32 v208, v64, v65
    v_cvt_pk_bf16_f32 v209, v66, v67
    v_cvt_pk_bf16_f32 v210, v68, v69
    v_cvt_pk_bf16_f32 v211, v70, v71
    buffer_store_dwordx4 v[208:211], v36, s[20:23], 0 offen offset:0 sc1 nt
    s_waitcnt lgkmcnt(0)
    s_barrier
    ds_read_b128 v[104:107], v23 offset:0
    ds_read_b128 v[108:111], v23 offset:1024
    ds_read_b128 v[112:115], v23 offset:2048
    ds_read_b128 v[116:119], v23 offset:3072
    ds_read_b128 v[120:123], v23 offset:4096
    ds_read_b128 v[124:127], v23 offset:5120
    s_waitcnt lgkmcnt(5)
    v_pk_add_f32 v[96:97], v[96:97], v[104:105]
    v_pk_add_f32 v[98:99], v[98:99], v[106:107]
    s_waitcnt lgkmcnt(4)
    v_pk_add_f32 v[100:101], v[100:101], v[108:109]
    v_pk_add_f32 v[102:103], v[102:103], v[110:111]
    s_waitcnt lgkmcnt(1)
    v_pk_add_f32 v[112:113], v[112:113], v[120:121]
    v_pk_add_f32 v[114:115], v[114:115], v[122:123]
    s_waitcnt lgkmcnt(0)
    v_pk_add_f32 v[116:117], v[116:117], v[124:125]
    v_pk_add_f32 v[118:119], v[118:119], v[126:127]
    v_pk_add_f32 v[96:97], v[96:97], v[112:113]
    v_pk_add_f32 v[98:99], v[98:99], v[114:115]
    v_pk_add_f32 v[100:101], v[100:101], v[116:117]
    v_pk_add_f32 v[102:103], v[102:103], v[118:119]
    v_cvt_pk_bf16_f32 v96, 0, v96
    v_cvt_pk_bf16_f32 v97, 0, v97
    v_cvt_pk_bf16_f32 v98, 0, v98
    v_cvt_pk_bf16_f32 v99, 0, v99
    v_cvt_pk_bf16_f32 v100, 0, v100
    v_cvt_pk_bf16_f32 v101, 0, v101
    v_cvt_pk_bf16_f32 v102, 0, v102
    v_cvt_pk_bf16_f32 v103, 0, v103
    v_pk_add_f32 v[96:97], v[96:97], v[36:37] op_sel:[0,1] op_sel_hi:[1,1]
    v_pk_add_f32 v[98:99], v[98:99], v[36:37] op_sel:[0,1] op_sel_hi:[1,1]
    v_pk_add_f32 v[100:101], v[100:101], v[36:37] op_sel:[0,1] op_sel_hi:[1,1]
    v_pk_add_f32 v[102:103], v[102:103], v[36:37] op_sel:[0,1] op_sel_hi:[1,1]
    s_mov_b32 s80, 0xbfb8aa3b
    v_cvt_pk_bf16_f32 v96, 0, v96
    v_cvt_pk_bf16_f32 v97, 0, v97
    v_cvt_pk_bf16_f32 v98, 0, v98
    v_cvt_pk_bf16_f32 v99, 0, v99
    v_cvt_pk_bf16_f32 v100, 0, v100
    v_cvt_pk_bf16_f32 v101, 0, v101
    v_cvt_pk_bf16_f32 v102, 0, v102
    v_cvt_pk_bf16_f32 v103, 0, v103
    v_pk_mul_f32 v[104:105], v[96:97], s[80:81] op_sel_hi:[1,0]
    v_pk_mul_f32 v[106:107], v[98:99], s[80:81] op_sel_hi:[1,0]
    v_pk_mul_f32 v[108:109], v[100:101], s[80:81] op_sel_hi:[1,0]
    v_pk_mul_f32 v[110:111], v[102:103], s[80:81] op_sel_hi:[1,0]
    v_exp_f32 v104, v104
    v_exp_f32 v105, v105
    v_exp_f32 v106, v106
    v_exp_f32 v107, v107
    v_exp_f32 v108, v108
    v_exp_f32 v109, v109
    v_exp_f32 v110, v110
    v_exp_f32 v111, v111
    v_pk_add_f32 v[104:105], v[104:105], 1.0 op_sel_hi:[1,0]
    v_pk_add_f32 v[106:107], v[106:107], 1.0 op_sel_hi:[1,0]
    v_pk_add_f32 v[108:109], v[108:109], 1.0 op_sel_hi:[1,0]
    v_pk_add_f32 v[110:111], v[110:111], 1.0 op_sel_hi:[1,0]
    v_rcp_f32 v104, v104
    v_rcp_f32 v105, v105
    v_rcp_f32 v106, v106
    v_rcp_f32 v107, v107
    v_rcp_f32 v108, v108
    v_rcp_f32 v109, v109
    v_rcp_f32 v110, v110
    v_rcp_f32 v111, v111
    v_pk_mul_f32 v[96:97], v[96:97], v[104:105]
    v_pk_mul_f32 v[98:99], v[98:99], v[106:107]
    v_pk_mul_f32 v[100:101], v[100:101], v[108:109]
    v_pk_mul_f32 v[102:103], v[102:103], v[110:111]
    v_cvt_pk_bf16_f32 v96, 0, v96
    v_cvt_pk_bf16_f32 v97, 0, v97
    v_cvt_pk_bf16_f32 v98, 0, v98
    v_cvt_pk_bf16_f32 v99, 0, v99
    v_cvt_pk_bf16_f32 v100, 0, v100
    v_cvt_pk_bf16_f32 v101, 0, v101
    v_cvt_pk_bf16_f32 v102, 0, v102
    v_cvt_pk_bf16_f32 v103, 0, v103
    v_pk_mul_f32 v[96:97], v[96:97], v[40:41]
    v_pk_mul_f32 v[98:99], v[98:99], v[42:43]
    v_pk_mul_f32 v[100:101], v[100:101], v[44:45]
    v_pk_mul_f32 v[102:103], v[102:103], v[46:47]
    v_cvt_pk_bf16_f32 v96, 0, v96
    v_cvt_pk_bf16_f32 v97, 0, v97
    v_cvt_pk_bf16_f32 v98, 0, v98
    v_cvt_pk_bf16_f32 v99, 0, v99
    v_cvt_pk_bf16_f32 v100, 0, v100
    v_cvt_pk_bf16_f32 v101, 0, v101
    v_cvt_pk_bf16_f32 v102, 0, v102
    v_cvt_pk_bf16_f32 v103, 0, v103
    v_pk_add_f32 v[96:97], v[96:97], v[48:49]
    v_pk_add_f32 v[98:99], v[98:99], v[50:51]
    v_pk_add_f32 v[100:101], v[100:101], v[52:53]
    v_pk_add_f32 v[102:103], v[102:103], v[54:55]
    v_cvt_pk_bf16_f32 v220, v96, v97
    v_cvt_pk_bf16_f32 v221, v98, v99
    v_cvt_pk_bf16_f32 v222, v100, v101
    v_cvt_pk_bf16_f32 v223, v102, v103
    buffer_store_dwordx4 v[220:223], v36, s[20:23], 0 offen offset:64 sc1 nt
    s_endpgm
L_fft:
    s_waitcnt lgkmcnt(2)
    v_mfma_f32_16x16x32_bf16 v[80:83], v[72:75], v[128:131], 0
    v_mfma_f32_16x16x32_bf16 v[88:91], v[72:75], v[132:135], 0
    s_waitcnt lgkmcnt(0)
    v_mfma_f32_16x16x32_bf16 v[84:87], v[76:79], v[128:131], 0
    v_mfma_f32_16x16x32_bf16 v[92:95], v[76:79], v[132:135], 0
    s_nop 3
    v_pk_mul_f32 v[96:97], v[80:81], v[136:137]
    v_pk_mul_f32 v[104:105], v[88:89], v[136:137]
    v_pk_mul_f32 v[98:99], v[82:83], v[138:139]
    v_pk_mul_f32 v[106:107], v[90:91], v[138:139]
    v_pk_fma_f32 v[96:97], v[88:89], v[140:141], v[96:97]
    v_pk_fma_f32 v[104:105], v[80:81], v[140:141], v[104:105] neg_lo:[1,0,0] neg_hi:[1,0,0]
    v_pk_fma_f32 v[98:99], v[90:91], v[142:143], v[98:99]
    v_pk_fma_f32 v[106:107], v[82:83], v[142:143], v[106:107] neg_lo:[1,0,0] neg_hi:[1,0,0]
    v_cvt_pk_bf16_f32 v112, v96, v97
    v_cvt_pk_bf16_f32 v114, v104, v105
    v_cvt_pk_bf16_f32 v113, v98, v99
    v_cvt_pk_bf16_f32 v115, v106, v107
    v_pk_mul_f32 v[100:101], v[84:85], v[136:137]
    v_pk_mul_f32 v[108:109], v[92:93], v[136:137]
    v_pk_mul_f32 v[102:103], v[86:87], v[138:139]
    v_pk_mul_f32 v[110:111], v[94:95], v[138:139]
    v_pk_fma_f32 v[100:101], v[92:93], v[140:141], v[100:101]
    v_pk_fma_f32 v[108:109], v[84:85], v[140:141], v[108:109] neg_lo:[1,0,0] neg_hi:[1,0,0]
    v_pk_fma_f32 v[102:103], v[94:95], v[142:143], v[102:103]
    v_pk_fma_f32 v[110:111], v[86:87], v[142:143], v[110:111] neg_lo:[1,0,0] neg_hi:[1,0,0]
    v_cvt_pk_bf16_f32 v116, v100, v101
    v_cvt_pk_bf16_f32 v118, v108, v109
    v_cvt_pk_bf16_f32 v117, v102, v103
    v_cvt_pk_bf16_f32 v119, v110, v111
    v_mfma_f32_16x16x32_bf16 v[164:167], v[144:147], v[112:115], 0
    v_mfma_f32_16x16x32_bf16 v[180:183], v[152:155], v[112:115], 0
    v_mfma_f32_16x16x32_bf16 v[172:175], v[148:151], v[112:115], 0
    v_mfma_f32_16x16x32_bf16 v[188:191], v[156:159], v[112:115], 0
    v_mfma_f32_16x16x32_bf16 v[168:171], v[144:147], v[116:119], 0
    v_mfma_f32_16x16x32_bf16 v[184:187], v[152:155], v[116:119], 0
    v_mfma_f32_16x16x32_bf16 v[176:179], v[148:151], v[116:119], 0
    v_mfma_f32_16x16x32_bf16 v[192:195], v[156:159], v[116:119], 0
    s_nop 1
    v_cndmask_b32 v164, v164, v180, s[90:91]
    v_cndmask_b32 v165, v165, v181, s[90:91]
    v_cndmask_b32 v166, v166, v182, s[90:91]
    v_cndmask_b32 v167, v167, v183, s[90:91]
    v_cndmask_b32 v168, v168, v184, s[90:91]
    v_cndmask_b32 v169, v169, v185, s[90:91]
    v_cndmask_b32 v170, v170, v186, s[90:91]
    v_cndmask_b32 v171, v171, v187, s[90:91]
    v_cndmask_b32 v172, v172, v188, s[90:91]
    v_cndmask_b32 v173, v173, v189, s[90:91]
    v_cndmask_b32 v174, v174, v190, s[90:91]
    v_cndmask_b32 v175, v175, v191, s[90:91]
    v_cndmask_b32 v176, v176, v192, s[90:91]
    v_cndmask_b32 v177, v177, v193, s[90:91]
    v_cndmask_b32 v178, v178, v194, s[90:91]
    v_cndmask_b32 v179, v179, v195, s[90:91]
    v_cvt_pk_bf16_f32 v80, v164, v168
    v_cvt_pk_bf16_f32 v81, v172, v176
    ds_write_b64 v160, v[80:81]
    v_cvt_pk_bf16_f32 v82, v165, v169
    v_cvt_pk_bf16_f32 v83, v173, v177
    ds_write_b64 v161, v[82:83]
    v_cvt_pk_bf16_f32 v84, v166, v170
    v_cvt_pk_bf16_f32 v85, v174, v178
    ds_write_b64 v162, v[84:85]
    v_cvt_pk_bf16_f32 v86, v167, v171
    v_cvt_pk_bf16_f32 v87, v175, v179
    ds_write_b64 v163, v[86:87]
    s_waitcnt vmcnt(0)
    s_atomic_swap s37, s[16:17], s56
    ds_read_b32 v39, v3
    s_waitcnt lgkmcnt(1)
    s_barrier
    ds_read_b128 v[64:67], v59
    ds_read_b128 v[68:71], v59 offset:1152
    s_waitcnt lgkmcnt(1)
    buffer_store_dwordx4 v[64:67], v60, s[16:19], s62 offen sc1
    ds_read_b32 v39, v3
    s_waitcnt lgkmcnt(1)
    buffer_store_dwordx4 v[68:71], v60, s[16:19], s63 offen sc1
    v_lshrrev_b32 v42, 3, v1
    v_and_b32 v43, 7, v1
    v_and_b32 v44, 2, v42
    v_xor_b32 v43, v43, v44
    s_mul_i32 s76, s36, 1835008
    s_lshl_b32 s78, s40, 7
    v_and_b32 v44, 4, v42
    v_mad_u32_u24 v44, v44, 3, v42
    v_lshlrev_b32 v44, 12, v44
    s_mov_b32 s48, s64
    s_add_u32 s76, s76, s78
    v_lshl_add_u32 v44, v43, 4, v44
    v_add_u32 v4, s76, v44
    s_mov_b32 s49, 7
    s_mov_b32 s50, 262144
    s_mov_b32 s51, 131072
    v_xor_b32 v44, 64, v4
    v_add_u32 v5, 15360, v44
    v_add_u32 v6, 30720, v4
    v_add_u32 v7, 46080, v44
    s_lshl_b32 s79, s36, 5
    v_bfe_u32 v42, v1, 2, 2
    v_lshrrev_b32 v43, 4, v1
    v_lshlrev_b32 v43, 10, v43
    v_lshl_add_u32 v43, v42, 7, v43
    v_and_b32 v44, 3, v1
    v_and_b32 v45, 24, v1
    v_lshlrev_b32 v45, 2, v45
    v_lshl_or_b32 v44, v44, 3, v45
    v_xor_b32 v44, s79, v44
    v_add3_u32 v12, v43, v44, s42
    v_xor_b32 v13, 32, v12
    v_xor_b32 v14, 64, v12
    v_xor_b32 v15, 96, v12
    s_add_u32 m0, s42, 8192
    s_mul_i32 s46, s48, s50
    buffer_load_dwordx4 v4, s[12:15], s46 offen offset:0 lds
    s_add_u32 s48, s48, 1
    s_cmp_eq_u32 s48, s49
    s_cselect_b32 s48, 0, s48
    v_lshlrev_b32 v40, 4, v1
    s_mul_i32 s76, s38, 262144
    s_mul_i32 s77, s36, 32768
    s_add_u32 s76, s76, s77
    s_add_u32 s76, s76, 2199552
    s_and_b32 s77, s36, 1
    s_lshl_b32 s77, s77, 10
    s_add_u32 s78, s76, s77
    s_sub_u32 s76, s76, s77
    v_add_u32 v16, s78, v40
    v_add_u32 v17, s76, v40
    v_add_u32 v18, 131072, v16
    v_add_u32 v19, 131072, v17
    s_mul_i32 s76, s38, 229376
    s_lshl2_add_u32 s77, s39, s36
    s_lshl_b32 s77, s77, 10
    s_add_u32 s76, s76, s77
    s_add_u32 s76, s76, 6590464
    v_add_u32 v35, s76, v40
    s_mul_i32 s76, s41, 229376
    s_mul_i32 s77, s36, 28672
    buffer_load_dwordx4 v5, s[12:15], s46 offen offset:1024 lds
    s_add_u32 s76, s76, s77
    s_add_u32 s76, s76, 6590464
    v_add_u32 v56, s76, v40
    v_add_u32 v57, 114688, v56
    s_xor_b32 s76, s36, 1
    s_mul_i32 s76, s76, 6144
    s_add_u32 s76, s76, 131072
    v_add_u32 v20, s76, v40
    s_xor_b32 s76, s36, 2
    s_mul_i32 s76, s76, 6144
    s_add_u32 s76, s76, 133120
    v_add_u32 v21, s76, v40
    s_xor_b32 s76, s36, 3
    s_mul_i32 s76, s76, 6144
    s_add_u32 s76, s76, 135168
    v_add_u32 v22, s76, v40
    s_mul_i32 s76, s36, 6144
    s_add_u32 s76, s76, 131072
    v_add_u32 v23, s76, v40
    v_lshrrev_b32 v41, 10, v36
    v_bfe_u32 v42, v36, 1, 9
    s_and_b32 s76, s41, 3
    s_cmp_lg_u32 s76, 0
    s_cselect_b64 s[90:91], 0, 0xffff
    s_cmp_eq_u32 s41, 0
    s_cselect_b32 s3, 0, 16
    s_cselect_b32 s89, 1060864, 0
    s_add_u32 s89, s89, 8785920
    s_cmp_ge_u32 s41, 4
    s_cselect_b32 s88, 0xffff, -1
    s_cselect_b64 s[92:93], -1, 0
    s_cselect_b32 s76, 3, 0
    s_xor_b32 s84, s76, 0
    buffer_load_dwordx4 v6, s[12:15], s46 offen offset:2048 lds
    s_lshl_b32 s84, s84, 13
    s_xor_b32 s85, s76, 1
    s_lshl_b32 s85, s85, 13
    s_xor_b32 s86, s76, 2
    s_lshl_b32 s86, s86, 13
    s_xor_b32 s87, s76, 3
    s_lshl_b32 s87, s87, 13
    v_sub_u32 v43, 2048, v41
    v_and_b32 v43, 2047, v43
    v_cndmask_b32 v43, v41, v43, s[92:93]
    v_lshlrev_b32 v44, 2, v43
    v_add_u32 v44, 8785920, v44
    v_lshrrev_b32 v41, 1, v42
    v_add_u32 v41, 0, v41
    v_sub_u32 v43, 256, v41
    v_and_b32 v45, 127, v43
    v_cndmask_b32 v45, v41, v45, s[92:93]
    v_lshl_add_u32 v58, v45, 13, v44
    v_add_u32 v41, 1, v41
    v_subrev_u32 v43, 4, v43
    v_cndmask_b32 v45, v41, v43, s[92:93]
    v_lshl_add_u32 v60, v45, 13, v44
    v_lshrrev_b32 v41, 1, v42
    v_add_u32 v41, 16, v41
    buffer_load_dwordx4 v7, s[12:15], s46 offen offset:3072 lds
    s_waitcnt vmcnt(4)
    s_atomic_swap s37, s[16:17], s57
    v_sub_u32 v43, 256, v41
    v_and_b32 v45, 127, v43
    v_cndmask_b32 v45, v41, v45, s[92:93]
    v_lshl_add_u32 v59, v45, 13, v44
    v_add_u32 v41, 1, v41
    v_subrev_u32 v43, 4, v43
    v_cndmask_b32 v45, v41, v43, s[92:93]
    v_lshl_add_u32 v61, v45, 13, v44
    s_lshl_b32 s76, s41, 3
    v_min_u32 v41, 7, v1
    v_add_u32 v41, s76, v41
    s_sub_u32 s76, 64, s76
    v_min_u32 v43, 8, v1
    v_sub_u32 v43, s76, v43
    v_and_b32 v43, 31, v43
    v_cndmask_b32 v41, v41, v43, s[92:93]
    v_lshlrev_b32 v41, 3, v41
    v_add_u32 v62, 557056, v41
    s_bfe_u32 s76, s2, 0x20001
    s_lshl2_add_u32 s76, s38, s76
    s_lshl_b32 s76, s76, 7
    s_add_u32 s58, s76, 327680
    s_and_b32 s76, s2, 3
    s_lshl3_add_u32 s76, s76, s41
    s_add_u32 m0, s42, 12288
    s_add_u32 s46, s46, s51
    buffer_load_dwordx4 v4, s[12:15], s46 offen offset:0 lds
    s_lshl2_add_u32 s76, s76, s36
    s_lshl_b32 s76, s76, 7
    s_add_u32 s59, s76, 327680
    s_add_u32 s65, s37, 28
    s_mov_b32 s95, 1
    s_barrier
    s_lshl2_add_u32 s39, s40, s36
    v_and_b32 v40, 31, v1
    v_lshrrev_b32 v41, 5, v1
    v_cvt_f32_ubyte0 v40, v40
    v_cvt_f32_ubyte0 v41, v41
    v_mul_f32 v42, 0x3d000000, v40
    v_mul_f32 v43, 4.0, v41
    v_mul_f32 v43, v43, v42
    v_fmamk_f32 v64, v42, 0x00000000, v43
    v_fmamk_f32 v65, v42, 0x3f800000, v43
    v_fmamk_f32 v66, v42, 0x40000000, v43
    v_fmamk_f32 v67, v42, 0x40400000, v43
    v_fmamk_f32 v68, v42, 0x41000000, v43
    v_fmamk_f32 v69, v42, 0x41100000, v43
    v_fmamk_f32 v70, v42, 0x41200000, v43
    v_fmamk_f32 v71, v42, 0x41300000, v43
    v_cos_f32 v72, v64
    v_sin_f32 v80, v64
    buffer_load_dwordx4 v5, s[12:15], s46 offen offset:1024 lds
    v_cos_f32 v73, v65
    v_sin_f32 v81, v65
    v_cos_f32 v74, v66
    v_sin_f32 v82, v66
    v_cos_f32 v75, v67
    v_sin_f32 v83, v67
    v_cos_f32 v76, v68
    v_sin_f32 v84, v68
    v_cos_f32 v77, v69
    v_sin_f32 v85, v69
    v_cos_f32 v78, v70
    v_sin_f32 v86, v70
    v_cos_f32 v79, v71
    v_sin_f32 v87, v71
    v_cvt_pk_bf16_f32 v88, v72, v73
    v_cvt_pk_bf16_f32 v89, v80, v81
    v_accvgpr_write_b32 a192, v88
    v_xor_b32 v90, 0x80008000, v89
    v_accvgpr_write_b32 a193, v89
    v_accvgpr_write_b32 a197, v88
    v_accvgpr_write_b32 a196, v90
    v_cvt_pk_bf16_f32 v88, v74, v75
    v_cvt_pk_bf16_f32 v89, v82, v83
    v_accvgpr_write_b32 a194, v88
    buffer_load_dwordx4 v6, s[12:15], s46 offen offset:2048 lds
    v_xor_b32 v90, 0x80008000, v89
    v_accvgpr_write_b32 a195, v89
    v_accvgpr_write_b32 a199, v88
    v_accvgpr_write_b32 a198, v90
    v_cvt_pk_bf16_f32 v88, v76, v77
    v_cvt_pk_bf16_f32 v89, v84, v85
    v_accvgpr_write_b32 a200, v88
    v_xor_b32 v90, 0x80008000, v89
    v_accvgpr_write_b32 a201, v89
    v_accvgpr_write_b32 a205, v88
    v_accvgpr_write_b32 a204, v90
    v_cvt_pk_bf16_f32 v88, v78, v79
    v_cvt_pk_bf16_f32 v89, v86, v87
    v_accvgpr_write_b32 a202, v88
    v_xor_b32 v90, 0x80008000, v89
    v_accvgpr_write_b32 a203, v89
    v_accvgpr_write_b32 a207, v88
    v_accvgpr_write_b32 a206, v90
    v_fmamk_f32 v64, v42, 0x41800000, v43
    v_fmamk_f32 v65, v42, 0x41880000, v43
    v_fmamk_f32 v66, v42, 0x41900000, v43
    v_fmamk_f32 v67, v42, 0x41980000, v43
    v_fmamk_f32 v68, v42, 0x41c00000, v43
    v_fmamk_f32 v69, v42, 0x41c80000, v43
    buffer_load_dwordx4 v7, s[12:15], s46 offen offset:3072 lds
    v_fmamk_f32 v70, v42, 0x41d00000, v43
    v_fmamk_f32 v71, v42, 0x41d80000, v43
    v_cos_f32 v72, v64
    v_sin_f32 v80, v64
    v_cos_f32 v73, v65
    v_sin_f32 v81, v65
    v_cos_f32 v74, v66
    v_sin_f32 v82, v66
    v_cos_f32 v75, v67
    v_sin_f32 v83, v67
    v_cos_f32 v76, v68
    v_sin_f32 v84, v68
    v_cos_f32 v77, v69
    v_sin_f32 v85, v69
    v_cos_f32 v78, v70
    v_sin_f32 v86, v70
    v_cos_f32 v79, v71
    v_sin_f32 v87, v71
    v_cvt_pk_bf16_f32 v88, v72, v73
    v_cvt_pk_bf16_f32 v89, v80, v81
    v_accvgpr_write_b32 a208, v88
    v_xor_b32 v90, 0x80008000, v89
    v_accvgpr_write_b32 a209, v89
    v_accvgpr_write_b32 a213, v88
    s_add_u32 m0, s42, 16384
    s_mul_i32 s46, s48, s50
    buffer_load_dwordx4 v4, s[12:15], s46 offen offset:0 lds
    s_add_u32 s48, s48, 1
    s_cmp_eq_u32 s48, s49
    s_cselect_b32 s48, 0, s48
    v_accvgpr_write_b32 a212, v90
    v_cvt_pk_bf16_f32 v88, v74, v75
    v_cvt_pk_bf16_f32 v89, v82, v83
    v_accvgpr_write_b32 a210, v88
    v_xor_b32 v90, 0x80008000, v89
    v_accvgpr_write_b32 a211, v89
    v_accvgpr_write_b32 a215, v88
    v_accvgpr_write_b32 a214, v90
    v_cvt_pk_bf16_f32 v88, v76, v77
    v_cvt_pk_bf16_f32 v89, v84, v85
    v_accvgpr_write_b32 a216, v88
    v_xor_b32 v90, 0x80008000, v89
    v_accvgpr_write_b32 a217, v89
    v_accvgpr_write_b32 a221, v88
    v_accvgpr_write_b32 a220, v90
    v_cvt_pk_bf16_f32 v88, v78, v79
    v_cvt_pk_bf16_f32 v89, v86, v87
    v_accvgpr_write_b32 a218, v88
    v_xor_b32 v90, 0x80008000, v89
    v_accvgpr_write_b32 a219, v89
    v_accvgpr_write_b32 a223, v88
    v_accvgpr_write_b32 a222, v90
    v_mul_f32 v42, 0x3c800000, v40
    v_mul_f32 v43, 4.0, v41
    buffer_load_dwordx4 v5, s[12:15], s46 offen offset:1024 lds
    v_mul_f32 v43, v43, v42
    v_fmamk_f32 v64, v42, 0x00000000, v43
    v_fmamk_f32 v65, v42, 0x40000000, v43
    v_fmamk_f32 v66, v42, 0x41000000, v43
    v_fmamk_f32 v67, v42, 0x41200000, v43
    v_fmamk_f32 v68, v42, 0x3f800000, v43
    v_fmamk_f32 v69, v42, 0x40400000, v43
    v_fmamk_f32 v70, v42, 0x41100000, v43
    v_fmamk_f32 v71, v42, 0x41300000, v43
    v_cos_f32 v72, v64
    v_sin_f32 v80, v64
    v_cos_f32 v73, v65
    v_sin_f32 v81, v65
    v_cos_f32 v74, v66
    v_sin_f32 v82, v66
    v_cos_f32 v75, v67
    v_sin_f32 v83, v67
    v_cos_f32 v76, v68
    v_sin_f32 v84, v68
    v_cos_f32 v77, v69
    v_sin_f32 v85, v69
    v_cos_f32 v78, v70
    v_sin_f32 v86, v70
    v_cos_f32 v79, v71
    buffer_load_dwordx4 v6, s[12:15], s46 offen offset:2048 lds
    v_sin_f32 v87, v71
    v_cvt_pk_bf16_f32 v88, v72, v73
    v_cvt_pk_bf16_f32 v90, v80, v81
    v_cvt_pk_bf16_f32 v89, v74, v75
    v_cvt_pk_bf16_f32 v91, v82, v83
    v_cvt_pk_bf16_f32 v92, v76, v77
    v_cvt_pk_bf16_f32 v94, v84, v85
    v_cvt_pk_bf16_f32 v93, v78, v79
    v_cvt_pk_bf16_f32 v95, v86, v87
    v_accvgpr_write_b32 a224, v88
    v_accvgpr_write_b32 a225, v89
    v_accvgpr_write_b32 a226, v90
    v_accvgpr_write_b32 a227, v91
    v_accvgpr_write_b32 a228, v92
    v_accvgpr_write_b32 a229, v93
    v_accvgpr_write_b32 a230, v94
    v_accvgpr_write_b32 a231, v95
    v_fmamk_f32 v64, v42, 0x41800000, v43
    v_fmamk_f32 v65, v42, 0x41900000, v43
    v_fmamk_f32 v66, v42, 0x41c00000, v43
    v_fmamk_f32 v67, v42, 0x41d00000, v43
    v_fmamk_f32 v68, v42, 0x41880000, v43
    v_fmamk_f32 v69, v42, 0x41980000, v43
    v_fmamk_f32 v70, v42, 0x41c80000, v43
    buffer_load_dwordx4 v7, s[12:15], s46 offen offset:3072 lds
    v_fmamk_f32 v71, v42, 0x41d80000, v43
    v_cos_f32 v72, v64
    v_sin_f32 v80, v64
    v_cos_f32 v73, v65
    v_sin_f32 v81, v65
    v_cos_f32 v74, v66
    v_sin_f32 v82, v66
    v_cos_f32 v75, v67
    v_sin_f32 v83, v67
    v_cos_f32 v76, v68
    v_sin_f32 v84, v68
    v_cos_f32 v77, v69
    v_sin_f32 v85, v69
    v_cos_f32 v78, v70
    v_sin_f32 v86, v70
    v_cos_f32 v79, v71
    v_sin_f32 v87, v71
    v_cvt_pk_bf16_f32 v88, v72, v73
    v_cvt_pk_bf16_f32 v90, v80, v81
    v_cvt_pk_bf16_f32 v89, v74, v75
    v_cvt_pk_bf16_f32 v91, v82, v83
    v_cvt_pk_bf16_f32 v92, v76, v77
    v_cvt_pk_bf16_f32 v94, v84, v85
    v_cvt_pk_bf16_f32 v93, v78, v79
    s_add_u32 m0, s42, 20480
    s_add_u32 s46, s46, s51
    buffer_load_dwordx4 v4, s[12:15], s46 offen offset:0 lds
    v_cvt_pk_bf16_f32 v95, v86, v87
    v_accvgpr_write_b32 a232, v88
    v_accvgpr_write_b32 a233, v89
    v_accvgpr_write_b32 a234, v90
    v_accvgpr_write_b32 a235, v91
    v_accvgpr_write_b32 a236, v92
    v_accvgpr_write_b32 a237, v93
    v_accvgpr_write_b32 a238, v94
    v_accvgpr_write_b32 a239, v95
    v_fmamk_f32 v64, v42, 0x42000000, v43
    v_fmamk_f32 v65, v42, 0x42080000, v43
    v_fmamk_f32 v66, v42, 0x42200000, v43
    v_fmamk_f32 v67, v42, 0x42280000, v43
    v_fmamk_f32 v68, v42, 0x42040000, v43
    v_fmamk_f32 v69, v42, 0x420c0000, v43
    v_fmamk_f32 v70, v42, 0x42240000, v43
    v_fmamk_f32 v71, v42, 0x422c0000, v43
    v_cos_f32 v72, v64
    v_sin_f32 v80, v64
    v_cos_f32 v73, v65
    v_sin_f32 v81, v65
    v_cos_f32 v74, v66
    v_sin_f32 v82, v66
    v_cos_f32 v75, v67
    buffer_load_dwordx4 v5, s[12:15], s46 offen offset:1024 lds
    v_sin_f32 v83, v67
    v_cos_f32 v76, v68
    v_sin_f32 v84, v68
    v_cos_f32 v77, v69
    v_sin_f32 v85, v69
    v_cos_f32 v78, v70
    v_sin_f32 v86, v70
    v_cos_f32 v79, v71
    v_sin_f32 v87, v71
    v_cvt_pk_bf16_f32 v88, v72, v73
    v_cvt_pk_bf16_f32 v90, v80, v81
    v_cvt_pk_bf16_f32 v89, v74, v75
    v_cvt_pk_bf16_f32 v91, v82, v83
    v_cvt_pk_bf16_f32 v92, v76, v77
    v_cvt_pk_bf16_f32 v94, v84, v85
    v_cvt_pk_bf16_f32 v93, v78, v79
    v_cvt_pk_bf16_f32 v95, v86, v87
    v_accvgpr_write_b32 a240, v88
    v_accvgpr_write_b32 a241, v89
    v_accvgpr_write_b32 a242, v90
    v_accvgpr_write_b32 a243, v91
    v_accvgpr_write_b32 a244, v92
    v_accvgpr_write_b32 a245, v93
    v_accvgpr_write_b32 a246, v94
    buffer_load_dwordx4 v6, s[12:15], s46 offen offset:2048 lds
    v_accvgpr_write_b32 a247, v95
    v_fmamk_f32 v64, v42, 0x42400000, v43
    v_fmamk_f32 v65, v42, 0x42480000, v43
    v_fmamk_f32 v66, v42, 0x42600000, v43
    v_fmamk_f32 v67, v42, 0x42680000, v43
    v_fmamk_f32 v68, v42, 0x42440000, v43
    v_fmamk_f32 v69, v42, 0x424c0000, v43
    v_fmamk_f32 v70, v42, 0x42640000, v43
    v_fmamk_f32 v71, v42, 0x426c0000, v43
    v_cos_f32 v72, v64
    v_sin_f32 v80, v64
    v_cos_f32 v73, v65
    v_sin_f32 v81, v65
    v_cos_f32 v74, v66
    v_sin_f32 v82, v66
    v_cos_f32 v75, v67
    v_sin_f32 v83, v67
    v_cos_f32 v76, v68
    v_sin_f32 v84, v68
    v_cos_f32 v77, v69
    v_sin_f32 v85, v69
    v_cos_f32 v78, v70
    v_sin_f32 v86, v70
    v_cos_f32 v79, v71
    buffer_load_dwordx4 v7, s[12:15], s46 offen offset:3072 lds
    v_sin_f32 v87, v71
    v_cvt_pk_bf16_f32 v88, v72, v73
    v_cvt_pk_bf16_f32 v90, v80, v81
    v_cvt_pk_bf16_f32 v89, v74, v75
    v_cvt_pk_bf16_f32 v91, v82, v83
    v_cvt_pk_bf16_f32 v92, v76, v77
    v_cvt_pk_bf16_f32 v94, v84, v85
    v_cvt_pk_bf16_f32 v93, v78, v79
    v_cvt_pk_bf16_f32 v95, v86, v87
    v_accvgpr_write_b32 a248, v88
    v_accvgpr_write_b32 a249, v89
    v_accvgpr_write_b32 a250, v90
    v_accvgpr_write_b32 a251, v91
    v_accvgpr_write_b32 a252, v92
    v_accvgpr_write_b32 a253, v93
    v_accvgpr_write_b32 a254, v94
    v_accvgpr_write_b32 a255, v95
    v_mul_f32 v42, 0x3a000000, v40
    v_mul_f32 v43, 4.0, v41
    v_mul_f32 v43, v43, v42
    v_fmamk_f32 v64, v42, 0x00000000, v43
    v_fmamk_f32 v65, v42, 0x3f800000, v43
    v_fmamk_f32 v66, v42, 0x40000000, v43
    v_fmamk_f32 v67, v42, 0x40400000, v43
    v_fmamk_f32 v68, v42, 0x41000000, v43
    v_fmamk_f32 v69, v42, 0x41100000, v43
    v_fmamk_f32 v70, v42, 0x41200000, v43
    v_fmamk_f32 v71, v42, 0x41300000, v43
    v_cos_f32 v160, v64
    v_sin_f32 v168, v64
    v_cos_f32 v161, v65
    v_sin_f32 v169, v65
    v_cos_f32 v162, v66
    v_sin_f32 v170, v66
    v_cos_f32 v163, v67
    v_sin_f32 v171, v67
    v_cos_f32 v164, v68
    v_sin_f32 v172, v68
    v_cos_f32 v165, v69
    v_sin_f32 v173, v69
    v_cos_f32 v166, v70
    v_sin_f32 v174, v70
    v_cos_f32 v167, v71
    v_sin_f32 v175, v71
    v_fmamk_f32 v64, v42, 0x41800000, v43
    v_fmamk_f32 v65, v42, 0x41880000, v43
    v_fmamk_f32 v66, v42, 0x41900000, v43
    v_fmamk_f32 v67, v42, 0x41980000, v43
    v_fmamk_f32 v68, v42, 0x41c00000, v43
    v_fmamk_f32 v69, v42, 0x41c80000, v43
    v_fmamk_f32 v70, v42, 0x41d00000, v43
    v_fmamk_f32 v71, v42, 0x41d80000, v43
    v_cos_f32 v176, v64
    v_sin_f32 v184, v64
    v_cos_f32 v177, v65
    v_sin_f32 v185, v65
    v_cos_f32 v178, v66
    v_sin_f32 v186, v66
    v_cos_f32 v179, v67
    v_sin_f32 v187, v67
    v_cos_f32 v180, v68
    v_sin_f32 v188, v68
    v_cos_f32 v181, v69
    v_sin_f32 v189, v69
    v_cos_f32 v182, v70
    v_sin_f32 v190, v70
    v_cos_f32 v183, v71
    v_sin_f32 v191, v71
    v_fmamk_f32 v64, v42, 0x42000000, v43
    v_fmamk_f32 v65, v42, 0x42040000, v43
    v_fmamk_f32 v66, v42, 0x42080000, v43
    v_fmamk_f32 v67, v42, 0x420c0000, v43
    v_fmamk_f32 v68, v42, 0x42200000, v43
    v_fmamk_f32 v69, v42, 0x42240000, v43
    v_fmamk_f32 v70, v42, 0x42280000, v43
    v_fmamk_f32 v71, v42, 0x422c0000, v43
    v_cos_f32 v192, v64
    v_sin_f32 v200, v64
    v_cos_f32 v193, v65
    v_sin_f32 v201, v65
    v_cos_f32 v194, v66
    v_sin_f32 v202, v66
    v_cos_f32 v195, v67
    v_sin_f32 v203, v67
    v_cos_f32 v196, v68
    v_sin_f32 v204, v68
    v_cos_f32 v197, v69
    v_sin_f32 v205, v69
    v_cos_f32 v198, v70
    v_sin_f32 v206, v70
    v_cos_f32 v199, v71
    v_sin_f32 v207, v71
    v_fmamk_f32 v64, v42, 0x42400000, v43
    v_fmamk_f32 v65, v42, 0x42440000, v43
    v_fmamk_f32 v66, v42, 0x42480000, v43
    v_fmamk_f32 v67, v42, 0x424c0000, v43
    v_fmamk_f32 v68, v42, 0x42600000, v43
    v_fmamk_f32 v69, v42, 0x42640000, v43
    v_fmamk_f32 v70, v42, 0x42680000, v43
    v_fmamk_f32 v71, v42, 0x426c0000, v43
    v_cos_f32 v208, v64
    v_sin_f32 v216, v64
    v_cos_f32 v209, v65
    v_sin_f32 v217, v65
    v_cos_f32 v210, v66
    v_sin_f32 v218, v66
    v_cos_f32 v211, v67
    v_sin_f32 v219, v67
    v_cos_f32 v212, v68
    v_sin_f32 v220, v68
    v_cos_f32 v213, v69
    v_sin_f32 v221, v69
    v_cos_f32 v214, v70
    v_sin_f32 v222, v70
    v_cos_f32 v215, v71
    v_sin_f32 v223, v71
    s_lshr_b32 s76, s39, 5
    s_lshl2_add_u32 s76, s76, s36
    s_lshl_b32 s76, s76, 10
    s_add_u32 s76, s76, 196608
    v_lshlrev_b32 v32, 4, v1
    v_and_b32 v44, 15, v1
    v_lshlrev_b32 v44, 6, v44
    v_bfe_u32 v45, v1, 4, 1
    v_lshl_add_u32 v44, v45, 5, v44
    v_lshrrev_b32 v45, 5, v1
    v_lshl_add_u32 v44, v45, 4, v44
    s_mov_b32 s43, 200000
L_poll_10:
    buffer_load_dword v48, v32, s[16:19], s76 offen sc1
    s_waitcnt vmcnt(0)
    v_cmp_ne_u32 vcc, v48, v2
    s_cbranch_vccz L_polled_11
    s_sub_u32 s43, s43, 1
    s_cbranch_scc0 L_poll_10
L_polled_11:
    s_barrier
    s_lshl_b32 s76, s39, 14
    s_add_u32 s76, s76, 4395008
    s_add_u32 s77, s76, 4096
    s_add_u32 s78, s76, 8192
    s_add_u32 s79, s76, 12288
    buffer_load_dwordx4 a[128:131], v44, s[16:19], s76 offen offset:0 sc1
    buffer_load_dwordx4 a[132:135], v44, s[16:19], s77 offen offset:0 sc1
    buffer_load_dwordx4 a[136:139], v44, s[16:19], s78 offen offset:0 sc1
    buffer_load_dwordx4 a[140:143], v44, s[16:19], s79 offen offset:0 sc1
    buffer_load_dwordx4 a[144:147], v44, s[16:19], s76 offen offset:1024 sc1
    buffer_load_dwordx4 a[148:151], v44, s[16:19], s77 offen offset:1024 sc1
    buffer_load_dwordx4 a[152:155], v44, s[16:19], s78 offen offset:1024 sc1
    buffer_load_dwordx4 a[156:159], v44, s[16:19], s79 offen offset:1024 sc1
    buffer_load_dwordx4 a[160:163], v44, s[16:19], s76 offen offset:2048 sc1
    buffer_load_dwordx4 a[164:167], v44, s[16:19], s77 offen offset:2048 sc1
    buffer_load_dwordx4 a[168:171], v44, s[16:19], s78 offen offset:2048 sc1
    buffer_load_dwordx4 a[172:175], v44, s[16:19], s79 offen offset:2048 sc1
    buffer_load_dwordx4 a[176:179], v44, s[16:19], s76 offen offset:3072 sc1
    buffer_load_dwordx4 a[180:183], v44, s[16:19], s77 offen offset:3072 sc1
    buffer_load_dwordx4 a[184:187], v44, s[16:19], s78 offen offset:3072 sc1
    buffer_load_dwordx4 a[188:191], v44, s[16:19], s79 offen offset:3072 sc1
    s_and_b32 s76, s40, 3
    s_lshl2_add_u32 s76, s36, s76
    s_mul_i32 s76, s76, 458752
    s_or_b32 s77, s40, 3
    s_lshl_b32 s77, s77, 7
    s_add_u32 s76, s76, s77
    v_min_u32 v32, 55, v1
    v_lshlrev_b32 v32, 12, v32
    s_add_u32 s77, s76, 229376
    s_cmp_lg_u32 s39, 0
    s_cbranch_scc1 L_non_12
    s_mov_b32 s43, 0
    s_atomic_swap s37, s[16:17], s43
L_non_12:
    s_waitcnt vmcnt(15)
    v_mfma_f32_32x32x16_bf16 v[64:79], a[128:131], a[192:195], 0
    v_mfma_f32_32x32x16_bf16 v[80:95], a[128:131], a[196:199], 0
    s_waitcnt vmcnt(14)
    v_mfma_f32_32x32x16_bf16 v[64:79], a[132:135], a[200:203], v[64:79]
    v_mfma_f32_32x32x16_bf16 v[80:95], a[132:135], a[204:207], v[80:95]
    s_waitcnt vmcnt(13)
    v_mfma_f32_32x32x16_bf16 v[64:79], a[136:139], a[208:211], v[64:79]
    v_mfma_f32_32x32x16_bf16 v[80:95], a[136:139], a[212:215], v[80:95]
    s_waitcnt vmcnt(12)
    v_mfma_f32_32x32x16_bf16 v[64:79], a[140:143], a[216:219], v[64:79]
    v_mfma_f32_32x32x16_bf16 v[80:95], a[140:143], a[220:223], v[80:95]
    s_waitcnt vmcnt(11)
    v_mfma_f32_32x32x16_bf16 v[224:239], a[144:147], a[192:195], 0
    s_nop 8
    v_mul_f32 v40, v64, v160
    v_mul_f32 v41, v65, v161
    v_mul_f32 v42, v66, v162
    v_mul_f32 v43, v67, v163
    v_mul_f32 v44, v68, v164
    v_mul_f32 v45, v69, v165
    v_mul_f32 v46, v70, v166
    v_mul_f32 v47, v71, v167
    v_mfma_f32_32x32x16_bf16 v[240:255], a[144:147], a[196:199], 0
    v_mul_f32 v48, v80, v160
    v_mul_f32 v49, v81, v161
    v_mul_f32 v50, v82, v162
    v_mul_f32 v51, v83, v163
    v_mul_f32 v52, v84, v164
    v_mul_f32 v53, v85, v165
    v_mul_f32 v54, v86, v166
    v_mul_f32 v55, v87, v167
    s_waitcnt vmcnt(10)
    v_mfma_f32_32x32x16_bf16 v[224:239], a[148:151], a[200:203], v[224:239]
    v_fmac_f32 v40, v80, v168
    v_fmac_f32 v41, v81, v169
    v_fmac_f32 v42, v82, v170
    v_fmac_f32 v43, v83, v171
    v_fmac_f32 v44, v84, v172
    v_fmac_f32 v45, v85, v173
    v_fmac_f32 v46, v86, v174
    v_fmac_f32 v47, v87, v175
    v_mfma_f32_32x32x16_bf16 v[240:255], a[148:151], a[204:207], v[240:255]
    v_fma_f32 v48, -v64, v168, v48
    v_fma_f32 v49, -v65, v169, v49
    v_fma_f32 v50, -v66, v170, v50
    v_fma_f32 v51, -v67, v171, v51
    v_fma_f32 v52, -v68, v172, v52
    v_fma_f32 v53, -v69, v173, v53
    v_fma_f32 v54, -v70, v174, v54
    v_fma_f32 v55, -v71, v175, v55
    s_waitcnt vmcnt(9)
    v_mfma_f32_32x32x16_bf16 v[224:239], a[152:155], a[208:211], v[224:239]
    v_cvt_pk_bf16_f32 v24, v40, v42
    v_cvt_pk_bf16_f32 v25, v44, v46
    v_cvt_pk_bf16_f32 v26, v48, v50
    v_cvt_pk_bf16_f32 v27, v52, v54
    v_cvt_pk_bf16_f32 v28, v41, v43
    v_cvt_pk_bf16_f32 v29, v45, v47
    v_cvt_pk_bf16_f32 v30, v49, v51
    v_cvt_pk_bf16_f32 v31, v53, v55
    v_mfma_f32_32x32x16_bf16 v[240:255], a[152:155], a[212:215], v[240:255]
    v_mfma_f32_32x32x16_bf16 v[96:111], v[24:27], a[224:227], 0
    v_mfma_f32_32x32x16_bf16 v[112:127], v[28:31], a[228:231], 0
    s_cmp_lg_u32 s39, 0
    s_cbranch_scc1 L_noim_13
    v_cvt_pk_bf16_f32 v24, v48, v50
    v_cvt_pk_bf16_f32 v26, -v40, -v42
    v_cvt_pk_bf16_f32 v25, v52, v54
    v_cvt_pk_bf16_f32 v27, -v44, -v46
    v_cvt_pk_bf16_f32 v28, v49, v51
    v_cvt_pk_bf16_f32 v30, -v41, -v43
    v_cvt_pk_bf16_f32 v29, v53, v55
    v_cvt_pk_bf16_f32 v31, -v45, -v47
    v_mfma_f32_32x32x16_bf16 a[64:79], v[24:27], a[224:227], 0
    s_nop 0
    v_mfma_f32_32x32x16_bf16 a[80:95], v[28:31], a[228:231], 0
L_noim_13:
    v_mul_f32 v40, v72, v160
    v_mul_f32 v41, v73, v161
    v_mul_f32 v42, v74, v162
    v_mul_f32 v43, v75, v163
    v_mul_f32 v44, v76, v164
    s_waitcnt vmcnt(8)
    v_mfma_f32_32x32x16_bf16 v[224:239], a[156:159], a[216:219], v[224:239]
    v_mul_f32 v45, v77, v165
    v_mul_f32 v46, v78, v166
    v_mul_f32 v47, v79, v167
    v_mul_f32 v48, v88, v160
    v_mul_f32 v49, v89, v161
    v_mul_f32 v50, v90, v162
    v_mul_f32 v51, v91, v163
    v_mul_f32 v52, v92, v164
    v_mfma_f32_32x32x16_bf16 v[240:255], a[156:159], a[220:223], v[240:255]
    v_mul_f32 v53, v93, v165
    v_mul_f32 v54, v94, v166
    v_mul_f32 v55, v95, v167
    v_fmac_f32 v40, v88, v168
    v_fmac_f32 v41, v89, v169
    v_fmac_f32 v42, v90, v170
    v_fmac_f32 v43, v91, v171
    v_fmac_f32 v44, v92, v172
    v_fmac_f32 v45, v93, v173
    v_fmac_f32 v46, v94, v174
    v_fmac_f32 v47, v95, v175
    v_fma_f32 v48, -v72, v168, v48
    v_fma_f32 v49, -v73, v169, v49
    v_fma_f32 v50, -v74, v170, v50
    v_fma_f32 v51, -v75, v171, v51
    v_fma_f32 v52, -v76, v172, v52
    v_fma_f32 v53, -v77, v173, v53
    v_fma_f32 v54, -v78, v174, v54
    v_fma_f32 v55, -v79, v175, v55
    v_cvt_pk_bf16_f32 v24, v40, v42
    v_cvt_pk_bf16_f32 v25, v44, v46
    v_cvt_pk_bf16_f32 v26, v48, v50
    v_cvt_pk_bf16_f32 v27, v52, v54
    v_cvt_pk_bf16_f32 v28, v41, v43
    v_cvt_pk_bf16_f32 v29, v45, v47
    v_cvt_pk_bf16_f32 v30, v49, v51
    v_cvt_pk_bf16_f32 v31, v53, v55
    v_mfma_f32_32x32x16_bf16 v[128:143], v[24:27], a[224:227], 0
    s_nop 0
    v_mfma_f32_32x32x16_bf16 v[144:159], v[28:31], a[228:231], 0
    s_waitcnt vmcnt(7)
    v_mfma_f32_32x32x16_bf16 v[64:79], a[160:163], a[192:195], 0
    v_mul_f32 v40, v224, v176
    v_mul_f32 v41, v225, v177
    v_mul_f32 v42, v226, v178
    v_mul_f32 v43, v227, v179
    v_mul_f32 v44, v228, v180
    v_mul_f32 v45, v229, v181
    v_mul_f32 v46, v230, v182
    v_mul_f32 v47, v231, v183
    v_mfma_f32_32x32x16_bf16 v[80:95], a[160:163], a[196:199], 0
    v_mul_f32 v48, v240, v176
    v_mul_f32 v49, v241, v177
    v_mul_f32 v50, v242, v178
    v_mul_f32 v51, v243, v179
    v_mul_f32 v52, v244, v180
    v_mul_f32 v53, v245, v181
    v_mul_f32 v54, v246, v182
    v_mul_f32 v55, v247, v183
    s_waitcnt vmcnt(6)
    v_mfma_f32_32x32x16_bf16 v[64:79], a[164:167], a[200:203], v[64:79]
    v_fmac_f32 v40, v240, v184
    v_fmac_f32 v41, v241, v185
    v_fmac_f32 v42, v242, v186
    v_fmac_f32 v43, v243, v187
    v_fmac_f32 v44, v244, v188
    v_fmac_f32 v45, v245, v189
    v_fmac_f32 v46, v246, v190
    v_fmac_f32 v47, v247, v191
    v_mfma_f32_32x32x16_bf16 v[80:95], a[164:167], a[204:207], v[80:95]
    v_fma_f32 v48, -v224, v184, v48
    v_fma_f32 v49, -v225, v185, v49
    v_fma_f32 v50, -v226, v186, v50
    v_fma_f32 v51, -v227, v187, v51
    v_fma_f32 v52, -v228, v188, v52
    v_fma_f32 v53, -v229, v189, v53
    v_fma_f32 v54, -v230, v190, v54
    v_fma_f32 v55, -v231, v191, v55
    s_waitcnt vmcnt(5)
    v_mfma_f32_32x32x16_bf16 v[64:79], a[168:171], a[208:211], v[64:79]
    v_cvt_pk_bf16_f32 v24, v40, v42
    v_cvt_pk_bf16_f32 v25, v44, v46
    v_cvt_pk_bf16_f32 v26, v48, v50
    v_cvt_pk_bf16_f32 v27, v52, v54
    v_cvt_pk_bf16_f32 v28, v41, v43
    v_cvt_pk_bf16_f32 v29, v45, v47
    v_cvt_pk_bf16_f32 v30, v49, v51
    v_cvt_pk_bf16_f32 v31, v53, v55
    v_mfma_f32_32x32x16_bf16 v[80:95], a[168:171], a[212:215], v[80:95]
    v_mfma_f32_32x32x16_bf16 v[96:111], v[24:27], a[232:235], v[96:111]
    v_mfma_f32_32x32x16_bf16 v[112:127], v[28:31], a[236:239], v[112:127]
    s_cmp_lg_u32 s39, 0
    s_cbranch_scc1 L_noim_14
    v_cvt_pk_bf16_f32 v24, v48, v50
    v_cvt_pk_bf16_f32 v26, -v40, -v42
    v_cvt_pk_bf16_f32 v25, v52, v54
    v_cvt_pk_bf16_f32 v27, -v44, -v46
    v_cvt_pk_bf16_f32 v28, v49, v51
    v_cvt_pk_bf16_f32 v30, -v41, -v43
    v_cvt_pk_bf16_f32 v29, v53, v55
    v_cvt_pk_bf16_f32 v31, -v45, -v47
    v_mfma_f32_32x32x16_bf16 a[64:79], v[24:27], a[232:235], a[64:79]
    s_nop 0
    v_mfma_f32_32x32x16_bf16 a[80:95], v[28:31], a[236:239], a[80:95]
L_noim_14:
    v_mul_f32 v40, v232, v176
    v_mul_f32 v41, v233, v177
    v_mul_f32 v42, v234, v178
    v_mul_f32 v43, v235, v179
    v_mul_f32 v44, v236, v180
    s_waitcnt vmcnt(4)
    v_mfma_f32_32x32x16_bf16 v[64:79], a[172:175], a[216:219], v[64:79]
    v_mul_f32 v45, v237, v181
    v_mul_f32 v46, v238, v182
    v_mul_f32 v47, v239, v183
    v_mul_f32 v48, v248, v176
    v_mul_f32 v49, v249, v177
    v_mul_f32 v50, v250, v178
    v_mul_f32 v51, v251, v179
    v_mul_f32 v52, v252, v180
    v_mfma_f32_32x32x16_bf16 v[80:95], a[172:175], a[220:223], v[80:95]
    v_mul_f32 v53, v253, v181
    v_mul_f32 v54, v254, v182
    v_mul_f32 v55, v255, v183
    v_fmac_f32 v40, v248, v184
    v_fmac_f32 v41, v249, v185
    v_fmac_f32 v42, v250, v186
    v_fmac_f32 v43, v251, v187
    v_fmac_f32 v44, v252, v188
    v_fmac_f32 v45, v253, v189
    v_fmac_f32 v46, v254, v190
    v_fmac_f32 v47, v255, v191
    v_fma_f32 v48, -v232, v184, v48
    v_fma_f32 v49, -v233, v185, v49
    v_fma_f32 v50, -v234, v186, v50
    v_fma_f32 v51, -v235, v187, v51
    v_fma_f32 v52, -v236, v188, v52
    v_fma_f32 v53, -v237, v189, v53
    v_fma_f32 v54, -v238, v190, v54
    v_fma_f32 v55, -v239, v191, v55
    v_cvt_pk_bf16_f32 v24, v40, v42
    v_cvt_pk_bf16_f32 v25, v44, v46
    v_cvt_pk_bf16_f32 v26, v48, v50
    v_cvt_pk_bf16_f32 v27, v52, v54
    v_cvt_pk_bf16_f32 v28, v41, v43
    v_cvt_pk_bf16_f32 v29, v45, v47
    v_cvt_pk_bf16_f32 v30, v49, v51
    v_cvt_pk_bf16_f32 v31, v53, v55
    v_mfma_f32_32x32x16_bf16 v[128:143], v[24:27], a[232:235], v[128:143]
    s_nop 0
    v_mfma_f32_32x32x16_bf16 v[144:159], v[28:31], a[236:239], v[144:159]
    buffer_load_dword v63, v32, s[12:15], s76 offen
    s_waitcnt vmcnt(4)
    v_mfma_f32_32x32x16_bf16 v[224:239], a[176:179], a[192:195], 0
    v_mul_f32 v40, v64, v192
    v_mul_f32 v41, v65, v193
    v_mul_f32 v42, v66, v194
    v_mul_f32 v43, v67, v195
    v_mul_f32 v44, v68, v196
    v_mul_f32 v45, v69, v197
    v_mul_f32 v46, v70, v198
    v_mul_f32 v47, v71, v199
    v_mfma_f32_32x32x16_bf16 v[240:255], a[176:179], a[196:199], 0
    v_mul_f32 v48, v80, v192
    v_mul_f32 v49, v81, v193
    v_mul_f32 v50, v82, v194
    v_mul_f32 v51, v83, v195
    v_mul_f32 v52, v84, v196
    v_mul_f32 v53, v85, v197
    v_mul_f32 v54, v86, v198
    v_mul_f32 v55, v87, v199
    s_waitcnt vmcnt(3)
    v_mfma_f32_32x32x16_bf16 v[224:239], a[180:183], a[200:203], v[224:239]
    v_fmac_f32 v40, v80, v200
    v_fmac_f32 v41, v81, v201
    v_fmac_f32 v42, v82, v202
    v_fmac_f32 v43, v83, v203
    v_fmac_f32 v44, v84, v204
    v_fmac_f32 v45, v85, v205
    v_fmac_f32 v46, v86, v206
    v_fmac_f32 v47, v87, v207
    v_mfma_f32_32x32x16_bf16 v[240:255], a[180:183], a[204:207], v[240:255]
    v_fma_f32 v48, -v64, v200, v48
    v_fma_f32 v49, -v65, v201, v49
    v_fma_f32 v50, -v66, v202, v50
    v_fma_f32 v51, -v67, v203, v51
    v_fma_f32 v52, -v68, v204, v52
    v_fma_f32 v53, -v69, v205, v53
    v_fma_f32 v54, -v70, v206, v54
    v_fma_f32 v55, -v71, v207, v55
    s_waitcnt vmcnt(2)
    v_mfma_f32_32x32x16_bf16 v[224:239], a[184:187], a[208:211], v[224:239]
    v_cvt_pk_bf16_f32 v24, v40, v42
    v_cvt_pk_bf16_f32 v25, v44, v46
    v_cvt_pk_bf16_f32 v26, v48, v50
    v_cvt_pk_bf16_f32 v27, v52, v54
    v_cvt_pk_bf16_f32 v28, v41, v43
    v_cvt_pk_bf16_f32 v29, v45, v47
    v_cvt_pk_bf16_f32 v30, v49, v51
    v_cvt_pk_bf16_f32 v31, v53, v55
    v_mfma_f32_32x32x16_bf16 v[240:255], a[184:187], a[212:215], v[240:255]
    v_mfma_f32_32x32x16_bf16 v[96:111], v[24:27], a[240:243], v[96:111]
    v_mfma_f32_32x32x16_bf16 v[112:127], v[28:31], a[244:247], v[112:127]
    s_cmp_lg_u32 s39, 0
    s_cbranch_scc1 L_noim_15
    v_cvt_pk_bf16_f32 v24, v48, v50
    v_cvt_pk_bf16_f32 v26, -v40, -v42
    v_cvt_pk_bf16_f32 v25, v52, v54
    v_cvt_pk_bf16_f32 v27, -v44, -v46
    v_cvt_pk_bf16_f32 v28, v49, v51
    v_cvt_pk_bf16_f32 v30, -v41, -v43
    v_cvt_pk_bf16_f32 v29, v53, v55
    v_cvt_pk_bf16_f32 v31, -v45, -v47
    v_mfma_f32_32x32x16_bf16 a[64:79], v[24:27], a[240:243], a[64:79]
    s_nop 0
    v_mfma_f32_32x32x16_bf16 a[80:95], v[28:31], a[244:247], a[80:95]
L_noim_15:
    v_mul_f32 v40, v72, v192
    v_mul_f32 v41, v73, v193
    v_mul_f32 v42, v74, v194
    v_mul_f32 v43, v75, v195
    v_mul_f32 v44, v76, v196
    s_waitcnt vmcnt(1)
    v_mfma_f32_32x32x16_bf16 v[224:239], a[188:191], a[216:219], v[224:239]
    v_mul_f32 v45, v77, v197
    v_mul_f32 v46, v78, v198
    v_mul_f32 v47, v79, v199
    v_mul_f32 v48, v88, v192
    v_mul_f32 v49, v89, v193
    v_mul_f32 v50, v90, v194
    v_mul_f32 v51, v91, v195
    v_mul_f32 v52, v92, v196
    v_mfma_f32_32x32x16_bf16 v[240:255], a[188:191], a[220:223], v[240:255]
    v_mul_f32 v53, v93, v197
    v_mul_f32 v54, v94, v198
    v_mul_f32 v55, v95, v199
    v_fmac_f32 v40, v88, v200
    v_fmac_f32 v41, v89, v201
    v_fmac_f32 v42, v90, v202
    v_fmac_f32 v43, v91, v203
    v_fmac_f32 v44, v92, v204
    v_fmac_f32 v45, v93, v205
    v_fmac_f32 v46, v94, v206
    v_fmac_f32 v47, v95, v207
    v_fma_f32 v48, -v72, v200, v48
    v_fma_f32 v49, -v73, v201, v49
    v_fma_f32 v50, -v74, v202, v50
    v_fma_f32 v51, -v75, v203, v51
    v_fma_f32 v52, -v76, v204, v52
    v_fma_f32 v53, -v77, v205, v53
    v_fma_f32 v54, -v78, v206, v54
    v_fma_f32 v55, -v79, v207, v55
    v_cvt_pk_bf16_f32 v24, v40, v42
    v_cvt_pk_bf16_f32 v25, v44, v46
    v_cvt_pk_bf16_f32 v26, v48, v50
    v_cvt_pk_bf16_f32 v27, v52, v54
    v_cvt_pk_bf16_f32 v28, v41, v43
    v_cvt_pk_bf16_f32 v29, v45, v47
    v_cvt_pk_bf16_f32 v30, v49, v51
    v_cvt_pk_bf16_f32 v31, v53, v55
    v_mfma_f32_32x32x16_bf16 v[128:143], v[24:27], a[240:243], v[128:143]
    s_nop 0
    v_mfma_f32_32x32x16_bf16 v[144:159], v[28:31], a[244:247], v[144:159]
    buffer_load_dword v63, v32, s[12:15], s77 offen
    v_mul_f32 v40, v224, v208
    v_mul_f32 v41, v225, v209
    v_mul_f32 v42, v226, v210
    v_mul_f32 v43, v227, v211
    v_mul_f32 v44, v228, v212
    v_mul_f32 v45, v229, v213
    v_mul_f32 v46, v230, v214
    v_mul_f32 v47, v231, v215
    v_mul_f32 v48, v240, v208
    v_mul_f32 v49, v241, v209
    v_mul_f32 v50, v242, v210
    v_mul_f32 v51, v243, v211
    v_mul_f32 v52, v244, v212
    v_mul_f32 v53, v245, v213
    v_mul_f32 v54, v246, v214
    v_mul_f32 v55, v247, v215
    v_fmac_f32 v40, v240, v216
    v_fmac_f32 v41, v241, v217
    v_fmac_f32 v42, v242, v218
    v_fmac_f32 v43, v243, v219
    v_fmac_f32 v44, v244, v220
    v_fmac_f32 v45, v245, v221
    v_fmac_f32 v46, v246, v222
    v_fmac_f32 v47, v247, v223
    v_fma_f32 v48, -v224, v216, v48
    v_fma_f32 v49, -v225, v217, v49
    v_fma_f32 v50, -v226, v218, v50
    v_fma_f32 v51, -v227, v219, v51
    v_fma_f32 v52, -v228, v220, v52
    v_fma_f32 v53, -v229, v221, v53
    v_fma_f32 v54, -v230, v222, v54
    v_fma_f32 v55, -v231, v223, v55
    v_cvt_pk_bf16_f32 v24, v40, v42
    v_cvt_pk_bf16_f32 v25, v44, v46
    v_cvt_pk_bf16_f32 v26, v48, v50
    v_cvt_pk_bf16_f32 v27, v52, v54
    v_cvt_pk_bf16_f32 v28, v41, v43
    v_cvt_pk_bf16_f32 v29, v45, v47
    v_cvt_pk_bf16_f32 v30, v49, v51
    v_cvt_pk_bf16_f32 v31, v53, v55
    v_mfma_f32_32x32x16_bf16 v[96:111], v[24:27], a[248:251], v[96:111]
    s_nop 0
    v_mfma_f32_32x32x16_bf16 v[112:127], v[28:31], a[252:255], v[112:127]
    s_cmp_lg_u32 s39, 0
    s_cbranch_scc1 L_noim_16
    v_cvt_pk_bf16_f32 v24, v48, v50
    v_cvt_pk_bf16_f32 v26, -v40, -v42
    v_cvt_pk_bf16_f32 v25, v52, v54
    v_cvt_pk_bf16_f32 v27, -v44, -v46
    v_cvt_pk_bf16_f32 v28, v49, v51
    v_cvt_pk_bf16_f32 v30, -v41, -v43
    v_cvt_pk_bf16_f32 v29, v53, v55
    v_cvt_pk_bf16_f32 v31, -v45, -v47
    v_mfma_f32_32x32x16_bf16 a[64:79], v[24:27], a[248:251], a[64:79]
    s_nop 0
    v_mfma_f32_32x32x16_bf16 a[80:95], v[28:31], a[252:255], a[80:95]
L_noim_16:
    v_mul_f32 v40, v232, v208
    v_mul_f32 v41, v233, v209
    v_mul_f32 v42, v234, v210
    v_mul_f32 v43, v235, v211
    v_mul_f32 v44, v236, v212
    v_mul_f32 v45, v237, v213
    v_mul_f32 v46, v238, v214
    v_mul_f32 v47, v239, v215
    v_mul_f32 v48, v248, v208
    v_mul_f32 v49, v249, v209
    v_mul_f32 v50, v250, v210
    v_mul_f32 v51, v251, v211
    v_mul_f32 v52, v252, v212
    v_mul_f32 v53, v253, v213
    v_mul_f32 v54, v254, v214
    v_mul_f32 v55, v255, v215
    v_fmac_f32 v40, v248, v216
    v_fmac_f32 v41, v249, v217
    v_fmac_f32 v42, v250, v218
    v_fmac_f32 v43, v251, v219
    v_fmac_f32 v44, v252, v220
    v_fmac_f32 v45, v253, v221
    v_fmac_f32 v46, v254, v222
    v_fmac_f32 v47, v255, v223
    v_fma_f32 v48, -v232, v216, v48
    v_fma_f32 v49, -v233, v217, v49
    v_fma_f32 v50, -v234, v218, v50
    v_fma_f32 v51, -v235, v219, v51
    v_fma_f32 v52, -v236, v220, v52
    v_fma_f32 v53, -v237, v221, v53
    v_fma_f32 v54, -v238, v222, v54
    v_fma_f32 v55, -v239, v223, v55
    v_cvt_pk_bf16_f32 v24, v40, v42
    v_cvt_pk_bf16_f32 v25, v44, v46
    v_cvt_pk_bf16_f32 v26, v48, v50
    v_cvt_pk_bf16_f32 v27, v52, v54
    v_cvt_pk_bf16_f32 v28, v41, v43
    v_cvt_pk_bf16_f32 v29, v45, v47
    v_cvt_pk_bf16_f32 v30, v49, v51
    v_cvt_pk_bf16_f32 v31, v53, v55
    v_mfma_f32_32x32x16_bf16 v[128:143], v[24:27], a[248:251], v[128:143]
    s_nop 0
    v_mfma_f32_32x32x16_bf16 v[144:159], v[28:31], a[252:255], v[144:159]
    s_lshl_b32 s76, s39, 13
    s_add_u32 s76, s76, 8785920
    s_add_u32 s77, s76, 4096
    s_cmp_lg_u32 s39, 0
    s_cbranch_scc1 L_noim_17
    v_and_b32 v44, 31, v1
    v_lshrrev_b32 v45, 5, v1
    v_lshlrev_b32 v45, 4, v45
    v_lshl_add_u32 v44, v44, 7, v45
    s_mov_b32 s78, 9846784
    s_mov_b32 s79, 9850880
    v_accvgpr_read_b32 v64, a64
    v_accvgpr_read_b32 v65, a65
    v_accvgpr_read_b32 v66, a66
    v_accvgpr_read_b32 v67, a67
    v_accvgpr_read_b32 v68, a68
    v_accvgpr_read_b32 v69, a69
    v_accvgpr_read_b32 v70, a70
    v_accvgpr_read_b32 v71, a71
    v_accvgpr_read_b32 v72, a72
    v_accvgpr_read_b32 v73, a73
    v_accvgpr_read_b32 v74, a74
    v_accvgpr_read_b32 v75, a75
    v_accvgpr_read_b32 v76, a76
    v_accvgpr_read_b32 v77, a77
    v_accvgpr_read_b32 v78, a78
    v_accvgpr_read_b32 v79, a79
    v_accvgpr_read_b32 v80, a80
    v_accvgpr_read_b32 v81, a81
    v_accvgpr_read_b32 v82, a82
    v_accvgpr_read_b32 v83, a83
    v_accvgpr_read_b32 v84, a84
    v_accvgpr_read_b32 v85, a85
    v_accvgpr_read_b32 v86, a86
    v_accvgpr_read_b32 v87, a87
    v_accvgpr_read_b32 v88, a88
    v_accvgpr_read_b32 v89, a89
    v_accvgpr_read_b32 v90, a90
    v_accvgpr_read_b32 v91, a91
    v_accvgpr_read_b32 v92, a92
    v_accvgpr_read_b32 v93, a93
    v_accvgpr_read_b32 v94, a94
    v_accvgpr_read_b32 v95, a95
    v_pk_add_f32 v[224:225], v[64:65], v[80:81]
    v_pk_add_f32 v[240:241], v[64:65], v[80:81] neg_lo:[0,1] neg_hi:[0,1]
    v_pk_add_f32 v[226:227], v[66:67], v[82:83]
    v_pk_add_f32 v[242:243], v[66:67], v[82:83] neg_lo:[0,1] neg_hi:[0,1]
    v_pk_add_f32 v[228:229], v[68:69], v[84:85]
    v_pk_add_f32 v[244:245], v[68:69], v[84:85] neg_lo:[0,1] neg_hi:[0,1]
    v_pk_add_f32 v[230:231], v[70:71], v[86:87]
    v_pk_add_f32 v[246:247], v[70:71], v[86:87] neg_lo:[0,1] neg_hi:[0,1]
    v_pk_add_f32 v[232:233], v[72:73], v[88:89]
    v_pk_add_f32 v[248:249], v[72:73], v[88:89] neg_lo:[0,1] neg_hi:[0,1]
    v_pk_add_f32 v[234:235], v[74:75], v[90:91]
    v_pk_add_f32 v[250:251], v[74:75], v[90:91] neg_lo:[0,1] neg_hi:[0,1]
    v_pk_add_f32 v[236:237], v[76:77], v[92:93]
    v_pk_add_f32 v[252:253], v[76:77], v[92:93] neg_lo:[0,1] neg_hi:[0,1]
    v_pk_add_f32 v[238:239], v[78:79], v[94:95]
    v_pk_add_f32 v[254:255], v[78:79], v[94:95] neg_lo:[0,1] neg_hi:[0,1]
    buffer_store_dwordx4 v[224:227], v44, s[16:19], s78 offen offset:0 sc1
    buffer_store_dwordx4 v[228:231], v44, s[16:19], s78 offen offset:32 sc1
    buffer_store_dwordx4 v[232:235], v44, s[16:19], s78 offen offset:64 sc1
    buffer_store_dwordx4 v[236:239], v44, s[16:19], s78 offen offset:96 sc1
    buffer_store_dwordx4 v[240:243], v44, s[16:19], s79 offen offset:0 sc1
    buffer_store_dwordx4 v[244:247], v44, s[16:19], s79 offen offset:32 sc1
    buffer_store_dwordx4 v[248:251], v44, s[16:19], s79 offen offset:64 sc1
    buffer_store_dwordx4 v[252:255], v44, s[16:19], s79 offen offset:96 sc1
L_noim_17:
    s_lshl_b32 s78, s36, 13
    s_add_u32 s78, s78, 131072
    v_lshrrev_b32 v44, 5, v1
    v_xor_b32 v44, v44, v1
    v_and_b32 v44, 7, v44
    v_and_b32 v45, 31, v1
    v_lshlrev_b32 v45, 7, v45
    v_lshl_add_u32 v44, v44, 4, v45
    v_add_u32 v44, s78, v44
    v_lshl_add_u32 v46, v1, 4, s78
    v_lshrrev_b32 v47, 3, v1
    v_lshlrev_b32 v47, 4, v47
    v_lshlrev_b32 v45, 4, v1
    v_xor_b32 v47, v47, v45
    v_pk_add_f32 v[48:49], v[96:97], v[112:113]
    v_pk_add_f32 v[52:53], v[128:129], v[144:145]
    v_pk_add_f32 v[50:51], v[98:99], v[114:115]
    v_pk_add_f32 v[54:55], v[130:131], v[146:147]
    v_cvt_pk_bf16_f32 v64, v48, v52
    v_cvt_pk_bf16_f32 v65, v49, v53
    v_cvt_pk_bf16_f32 v66, v50, v54
    v_cvt_pk_bf16_f32 v67, v51, v55
    ds_write_b128 v44, v[64:67] offset:0
    v_pk_add_f32 v[48:49], v[96:97], v[112:113] neg_lo:[0,1] neg_hi:[0,1]
    v_pk_add_f32 v[52:53], v[128:129], v[144:145] neg_lo:[0,1] neg_hi:[0,1]
    v_pk_add_f32 v[50:51], v[98:99], v[114:115] neg_lo:[0,1] neg_hi:[0,1]
    v_pk_add_f32 v[54:55], v[130:131], v[146:147] neg_lo:[0,1] neg_hi:[0,1]
    v_cvt_pk_bf16_f32 v68, v48, v52
    v_cvt_pk_bf16_f32 v69, v49, v53
    v_cvt_pk_bf16_f32 v70, v50, v54
    v_cvt_pk_bf16_f32 v71, v51, v55
    ds_write_b128 v44, v[68:71] offset:4096
    v_xor_b32 v45, 32, v44
    v_pk_add_f32 v[48:49], v[100:101], v[116:117]
    v_pk_add_f32 v[52:53], v[132:133], v[148:149]
    v_pk_add_f32 v[50:51], v[102:103], v[118:119]
    v_pk_add_f32 v[54:55], v[134:135], v[150:151]
    v_cvt_pk_bf16_f32 v72, v48, v52
    v_cvt_pk_bf16_f32 v73, v49, v53
    v_cvt_pk_bf16_f32 v74, v50, v54
    v_cvt_pk_bf16_f32 v75, v51, v55
    ds_write_b128 v45, v[72:75] offset:0
    v_pk_add_f32 v[48:49], v[100:101], v[116:117] neg_lo:[0,1] neg_hi:[0,1]
    v_pk_add_f32 v[52:53], v[132:133], v[148:149] neg_lo:[0,1] neg_hi:[0,1]
    v_pk_add_f32 v[50:51], v[102:103], v[118:119] neg_lo:[0,1] neg_hi:[0,1]
    v_pk_add_f32 v[54:55], v[134:135], v[150:151] neg_lo:[0,1] neg_hi:[0,1]
    v_cvt_pk_bf16_f32 v76, v48, v52
    v_cvt_pk_bf16_f32 v77, v49, v53
    v_cvt_pk_bf16_f32 v78, v50, v54
    v_cvt_pk_bf16_f32 v79, v51, v55
    ds_write_b128 v45, v[76:79] offset:4096
    v_xor_b32 v45, 64, v44
    v_pk_add_f32 v[48:49], v[104:105], v[120:121]
    v_pk_add_f32 v[52:53], v[136:137], v[152:153]
    v_pk_add_f32 v[50:51], v[106:107], v[122:123]
    v_pk_add_f32 v[54:55], v[138:139], v[154:155]
    v_cvt_pk_bf16_f32 v80, v48, v52
    v_cvt_pk_bf16_f32 v81, v49, v53
    v_cvt_pk_bf16_f32 v82, v50, v54
    v_cvt_pk_bf16_f32 v83, v51, v55
    ds_write_b128 v45, v[80:83] offset:0
    v_pk_add_f32 v[48:49], v[104:105], v[120:121] neg_lo:[0,1] neg_hi:[0,1]
    v_pk_add_f32 v[52:53], v[136:137], v[152:153] neg_lo:[0,1] neg_hi:[0,1]
    v_pk_add_f32 v[50:51], v[106:107], v[122:123] neg_lo:[0,1] neg_hi:[0,1]
    v_pk_add_f32 v[54:55], v[138:139], v[154:155] neg_lo:[0,1] neg_hi:[0,1]
    v_cvt_pk_bf16_f32 v84, v48, v52
    v_cvt_pk_bf16_f32 v85, v49, v53
    v_cvt_pk_bf16_f32 v86, v50, v54
    v_cvt_pk_bf16_f32 v87, v51, v55
    ds_write_b128 v45, v[84:87] offset:4096
    v_xor_b32 v45, 96, v44
    v_pk_add_f32 v[48:49], v[108:109], v[124:125]
    v_pk_add_f32 v[52:53], v[140:141], v[156:157]
    v_pk_add_f32 v[50:51], v[110:111], v[126:127]
    v_pk_add_f32 v[54:55], v[142:143], v[158:159]
    v_cvt_pk_bf16_f32 v88, v48, v52
    v_cvt_pk_bf16_f32 v89, v49, v53
    v_cvt_pk_bf16_f32 v90, v50, v54
    v_cvt_pk_bf16_f32 v91, v51, v55
    ds_write_b128 v45, v[88:91] offset:0
    v_pk_add_f32 v[48:49], v[108:109], v[124:125] neg_lo:[0,1] neg_hi:[0,1]
    v_pk_add_f32 v[52:53], v[140:141], v[156:157] neg_lo:[0,1] neg_hi:[0,1]
    v_pk_add_f32 v[50:51], v[110:111], v[126:127] neg_lo:[0,1] neg_hi:[0,1]
    v_pk_add_f32 v[54:55], v[142:143], v[158:159] neg_lo:[0,1] neg_hi:[0,1]
    v_cvt_pk_bf16_f32 v92, v48, v52
    v_cvt_pk_bf16_f32 v93, v49, v53
    v_cvt_pk_bf16_f32 v94, v50, v54
    v_cvt_pk_bf16_f32 v95, v51, v55
    ds_write_b128 v45, v[92:95] offset:4096
    ds_read_b32 v39, v3
    ds_read_b32 v39, v3
    ds_read_b32 v39, v3
    s_waitcnt lgkmcnt(3)
    ds_read_b128 v[96:99], v46 offset:0
    ds_read_b128 v[100:103], v46 offset:1024
    ds_read_b128 v[104:107], v46 offset:2048
    ds_read_b128 v[108:111], v46 offset:3072
    ds_read_b128 v[112:115], v46 offset:4096
    ds_read_b128 v[116:119], v46 offset:5120
    ds_read_b128 v[120:123], v46 offset:6144
    ds_read_b128 v[124:127], v46 offset:7168
    s_waitcnt lgkmcnt(7)
    buffer_store_dwordx4 v[96:99], v47, s[16:19], s76 offen offset:0 sc1
    s_waitcnt lgkmcnt(6)
    buffer_store_dwordx4 v[100:103], v47, s[16:19], s76 offen offset:1024 sc1
    s_waitcnt lgkmcnt(5)
    buffer_store_dwordx4 v[104:107], v47, s[16:19], s76 offen offset:2048 sc1
    s_waitcnt lgkmcnt(4)
    buffer_store_dwordx4 v[108:111], v47, s[16:19], s76 offen offset:3072 sc1
    s_waitcnt lgkmcnt(3)
    buffer_store_dwordx4 v[112:115], v47, s[16:19], s77 offen offset:0 sc1
    ds_read_b32 v39, v3
    s_waitcnt lgkmcnt(3)
    buffer_store_dwordx4 v[116:119], v47, s[16:19], s77 offen offset:1024 sc1
    ds_read_b32 v39, v3
    s_waitcnt lgkmcnt(3)
    buffer_store_dwordx4 v[120:123], v47, s[16:19], s77 offen offset:2048 sc1
    ds_read_b32 v39, v3
    s_waitcnt lgkmcnt(3)
    buffer_store_dwordx4 v[124:127], v47, s[16:19], s77 offen offset:3072 sc1
    s_barrier
    s_lshl_b32 s78, s40, 3
    s_add_u32 s58, s78, 557056
    buffer_load_dwordx4 v[208:211], v36, s[4:7], 0 offen offset:0
    buffer_load_dwordx4 v[220:223], v36, s[4:7], 0 offen offset:64
    s_lshl_b32 s45, s64, 12
    v_lshlrev_b32 v37, 16, v37
    ds_read_b64_tr_b16 a[0:1], v12 offset:8192
    ds_read_b64_tr_b16 a[2:3], v12 offset:8704
    ds_read_b64_tr_b16 a[4:5], v13 offset:8192
    s_add_u32 m0, s42, 24576
    s_mul_i32 s46, s48, s50
    buffer_load_dwordx4 v4, s[12:15], s46 offen offset:0 lds
    s_add_u32 s48, s48, 1
    s_cmp_eq_u32 s48, s49
    s_cselect_b32 s48, 0, s48
    ds_read_b64_tr_b16 a[6:7], v13 offset:8704
    ds_read_b64_tr_b16 a[8:9], v14 offset:8192
    ds_read_b64_tr_b16 a[10:11], v14 offset:8704
    buffer_load_dwordx4 v5, s[12:15], s46 offen offset:1024 lds
    ds_read_b64_tr_b16 a[12:13], v15 offset:8192
    ds_read_b64_tr_b16 a[14:15], v15 offset:8704
    buffer_load_dwordx4 v6, s[12:15], s46 offen offset:2048 lds
    buffer_load_dwordx4 v7, s[12:15], s46 offen offset:3072 lds
    ds_read_b64_tr_b16 a[16:17], v12 offset:12288
    ds_read_b64_tr_b16 a[18:19], v12 offset:12800
    ds_read_b64_tr_b16 a[20:21], v13 offset:12288
    s_add_u32 m0, s42, 28672
    s_add_u32 s46, s46, s51
    buffer_load_dwordx4 v4, s[12:15], s46 offen offset:0 lds
    ds_read_b64_tr_b16 a[22:23], v13 offset:12800
    ds_read_b64_tr_b16 a[24:25], v14 offset:12288
    ds_read_b64_tr_b16 a[26:27], v14 offset:12800
    buffer_load_dwordx4 v5, s[12:15], s46 offen offset:1024 lds
    ds_read_b64_tr_b16 a[28:29], v15 offset:12288
    ds_read_b64_tr_b16 a[30:31], v15 offset:12800
    buffer_load_dwordx4 v6, s[12:15], s46 offen offset:2048 lds
    buffer_load_dwordx4 v7, s[12:15], s46 offen offset:3072 lds
    s_waitcnt vmcnt(10)
    s_barrier
    s_cmp_lg_u32 s36, 0
    s_cbranch_scc1 L_noflag_18
    s_atomic_swap s37, s[16:17], s58
L_noflag_18:
    s_add_u32 m0, s42, 0
    s_mul_i32 s46, s48, s50
    buffer_load_dwordx4 v4, s[12:15], s46 offen offset:0 lds
    s_add_u32 s48, s48, 1
    s_cmp_eq_u32 s48, s49
    s_cselect_b32 s48, 0, s48
    ds_read_b64_tr_b16 a[32:33], v12 offset:16384
    ds_read_b64_tr_b16 a[34:35], v12 offset:16896
    ds_read_b64_tr_b16 a[36:37], v13 offset:16384
    buffer_load_dwordx4 v5, s[12:15], s46 offen offset:1024 lds
    ds_read_b64_tr_b16 a[38:39], v13 offset:16896
    ds_read_b64_tr_b16 a[40:41], v14 offset:16384
    ds_read_b64_tr_b16 a[42:43], v14 offset:16896
    buffer_load_dwordx4 v6, s[12:15], s46 offen offset:2048 lds
    ds_read_b64_tr_b16 a[44:45], v15 offset:16384
    ds_read_b64_tr_b16 a[46:47], v15 offset:16896
    buffer_load_dwordx4 v7, s[12:15], s46 offen offset:3072 lds
    ds_read_b64_tr_b16 a[48:49], v12 offset:20480
    ds_read_b64_tr_b16 a[50:51], v12 offset:20992
    ds_read_b64_tr_b16 a[52:53], v13 offset:20480
    s_add_u32 m0, s42, 4096
    s_add_u32 s46, s46, s51
    buffer_load_dwordx4 v4, s[12:15], s46 offen offset:0 lds
    ds_read_b64_tr_b16 a[54:55], v13 offset:20992
    ds_read_b64_tr_b16 a[56:57], v14 offset:20480
    ds_read_b64_tr_b16 a[58:59], v14 offset:20992
    buffer_load_dwordx4 v5, s[12:15], s46 offen offset:1024 lds
    ds_read_b64_tr_b16 a[60:61], v15 offset:20480
    ds_read_b64_tr_b16 a[62:63], v15 offset:20992
    buffer_load_dwordx4 v6, s[12:15], s46 offen offset:2048 lds
    buffer_load_dwordx4 v7, s[12:15], s46 offen offset:3072 lds
    s_waitcnt vmcnt(12)
    ds_read_b64_tr_b16 a[64:65], v12 offset:24576
    ds_read_b64_tr_b16 a[66:67], v12 offset:25088
    ds_read_b64_tr_b16 a[68:69], v13 offset:24576
    s_waitcnt lgkmcnt(15)
    s_add_u32 m0, s42, 8192
    s_mul_i32 s46, s48, s50
    buffer_load_dwordx4 v4, s[12:15], s46 offen offset:0 lds
    s_add_u32 s48, s48, 1
    s_cmp_eq_u32 s48, s49
    s_cselect_b32 s48, 0, s48
    ds_read_b64_tr_b16 a[70:71], v13 offset:25088
    ds_read_b64_tr_b16 a[72:73], v14 offset:24576
    ds_read_b64_tr_b16 a[74:75], v14 offset:25088
    buffer_load_dwordx4 v5, s[12:15], s46 offen offset:1024 lds
    ds_read_b64_tr_b16 a[76:77], v15 offset:24576
    ds_read_b64_tr_b16 a[78:79], v15 offset:25088
    buffer_load_dwordx4 v6, s[12:15], s46 offen offset:2048 lds
    buffer_load_dwordx4 v7, s[12:15], s46 offen offset:3072 lds
    s_waitcnt vmcnt(12)
    ds_read_b64_tr_b16 a[80:81], v12 offset:28672
    ds_read_b64_tr_b16 a[82:83], v12 offset:29184
    ds_read_b64_tr_b16 a[84:85], v13 offset:28672
    s_add_u32 m0, s42, 12288
    s_add_u32 s46, s46, s51
    buffer_load_dwordx4 v4, s[12:15], s46 offen offset:0 lds
    ds_read_b64_tr_b16 a[86:87], v13 offset:29184
    ds_read_b64_tr_b16 a[88:89], v14 offset:28672
    ds_read_b64_tr_b16 a[90:91], v14 offset:29184
    buffer_load_dwordx4 v5, s[12:15], s46 offen offset:1024 lds
    ds_read_b64_tr_b16 a[92:93], v15 offset:28672
    ds_read_b64_tr_b16 a[94:95], v15 offset:29184
    buffer_load_dwordx4 v6, s[12:15], s46 offen offset:2048 lds
    buffer_load_dwordx4 v7, s[12:15], s46 offen offset:3072 lds
    s_waitcnt vmcnt(12)
    ds_read_b64_tr_b16 a[96:97], v12 offset:0
    ds_read_b64_tr_b16 a[98:99], v12 offset:512
    ds_read_b64_tr_b16 a[100:101], v13 offset:0
    s_waitcnt lgkmcnt(15)
    s_add_u32 m0, s42, 16384
    s_mul_i32 s46, s48, s50
    buffer_load_dwordx4 v4, s[12:15], s46 offen offset:0 lds
    s_add_u32 s48, s48, 1
    s_cmp_eq_u32 s48, s49
    s_cselect_b32 s48, 0, s48
    ds_read_b64_tr_b16 a[102:103], v13 offset:512
    ds_read_b64_tr_b16 a[104:105], v14 offset:0
    ds_read_b64_tr_b16 a[106:107], v14 offset:512
    buffer_load_dwordx4 v5, s[12:15], s46 offen offset:1024 lds
    ds_read_b64_tr_b16 a[108:109], v15 offset:0
    ds_read_b64_tr_b16 a[110:111], v15 offset:512
    buffer_load_dwordx4 v6, s[12:15], s46 offen offset:2048 lds
    buffer_load_dwordx4 v7, s[12:15], s46 offen offset:3072 lds
    s_waitcnt vmcnt(12)
    ds_read_b64_tr_b16 a[112:113], v12 offset:4096
    ds_read_b64_tr_b16 a[114:115], v12 offset:4608
    ds_read_b64_tr_b16 a[116:117], v13 offset:4096
    s_add_u32 m0, s42, 20480
    s_add_u32 s46, s46, s51
    buffer_load_dwordx4 v4, s[12:15], s46 offen offset:0 lds
    ds_read_b64_tr_b16 a[118:119], v13 offset:4608
    ds_read_b64_tr_b16 a[120:121], v14 offset:4096
    ds_read_b64_tr_b16 a[122:123], v14 offset:4608
    buffer_load_dwordx4 v5, s[12:15], s46 offen offset:1024 lds
    ds_read_b64_tr_b16 a[124:125], v15 offset:4096
    ds_read_b64_tr_b16 a[126:127], v15 offset:4608
    s_load_dword s94, s[16:17], s59 glc
    buffer_load_dwordx4 v6, s[12:15], s46 offen offset:2048 lds
    buffer_load_dwordx4 v7, s[12:15], s46 offen offset:3072 lds
    s_waitcnt vmcnt(12)
    ds_read_b64_tr_b16 a[128:129], v12 offset:8192
    ds_read_b64_tr_b16 a[130:131], v12 offset:8704
    ds_read_b64_tr_b16 a[132:133], v13 offset:8192
    s_waitcnt lgkmcnt(15)
    s_add_u32 m0, s42, 24576
    s_mul_i32 s46, s48, s50
    buffer_load_dwordx4 v4, s[12:15], s46 offen offset:0 lds
    s_add_u32 s48, s48, 1
    s_cmp_eq_u32 s48, s49
    s_cselect_b32 s48, 0, s48
    ds_read_b64_tr_b16 a[134:135], v13 offset:8704
    ds_read_b64_tr_b16 a[136:137], v14 offset:8192
    ds_read_b64_tr_b16 a[138:139], v14 offset:8704
    buffer_load_dwordx4 v5, s[12:15], s46 offen offset:1024 lds
    ds_read_b64_tr_b16 a[140:141], v15 offset:8192
    ds_read_b64_tr_b16 a[142:143], v15 offset:8704
    buffer_load_dwordx4 v6, s[12:15], s46 offen offset:2048 lds
    buffer_load_dwordx4 v7, s[12:15], s46 offen offset:3072 lds
    s_waitcnt vmcnt(12)
    ds_read_b64_tr_b16 a[144:145], v12 offset:12288
    ds_read_b64_tr_b16 a[146:147], v12 offset:12800
    ds_read_b64_tr_b16 a[148:149], v13 offset:12288
    s_add_u32 m0, s42, 28672
    s_add_u32 s46, s46, s51
    buffer_load_dwordx4 v4, s[12:15], s46 offen offset:0 lds
    ds_read_b64_tr_b16 a[150:151], v13 offset:12800
    ds_read_b64_tr_b16 a[152:153], v14 offset:12288
    ds_read_b64_tr_b16 a[154:155], v14 offset:12800
    buffer_load_dwordx4 v5, s[12:15], s46 offen offset:1024 lds
    ds_read_b64_tr_b16 a[156:157], v15 offset:12288
    ds_read_b64_tr_b16 a[158:159], v15 offset:12800
    buffer_load_dwordx4 v6, s[12:15], s46 offen offset:2048 lds
    buffer_load_dwordx4 v7, s[12:15], s46 offen offset:3072 lds
    s_waitcnt vmcnt(12)
    ds_read_b64_tr_b16 a[160:161], v12 offset:16384
    ds_read_b64_tr_b16 a[162:163], v12 offset:16896
    ds_read_b64_tr_b16 a[164:165], v13 offset:16384
    s_waitcnt lgkmcnt(0)
    s_cmp_eq_u32 s94, s65
    s_cbranch_scc1 L_counted_20
    s_mov_b32 s43, 200000
L_cnt_19:
    s_load_dword s94, s[16:17], s59 glc
    s_waitcnt lgkmcnt(0)
    s_cmp_eq_u32 s94, s65
    s_cbranch_scc1 L_counted_20
    s_sub_u32 s43, s43, 1
    s_cbranch_scc0 L_cnt_19
L_counted_20:
    buffer_load_dwordx4 v[128:131], v56, s[16:19], s45 offen offset:0 sc1
    ds_read_b64_tr_b16 a[166:167], v13 offset:16896
    ds_read_b64_tr_b16 a[168:169], v14 offset:16384
    ds_read_b64_tr_b16 a[170:171], v14 offset:16896
    ds_read_b64_tr_b16 a[172:173], v15 offset:16384
    buffer_load_dwordx4 v[132:135], v56, s[16:19], s45 offen offset:1024 sc1
    ds_read_b64_tr_b16 a[174:175], v15 offset:16896
    s_waitcnt vmcnt(10)
    ds_read_b64_tr_b16 a[176:177], v12 offset:20480
    ds_read_b64_tr_b16 a[178:179], v12 offset:20992
    ds_read_b64_tr_b16 a[180:181], v13 offset:20480
    buffer_load_dwordx4 v[136:139], v56, s[16:19], s45 offen offset:2048 sc1
    ds_read_b64_tr_b16 a[182:183], v13 offset:20992
    ds_read_b64_tr_b16 a[184:185], v14 offset:20480
    ds_read_b64_tr_b16 a[186:187], v14 offset:20992
    ds_read_b64_tr_b16 a[188:189], v15 offset:20480
    buffer_load_dwordx4 v[140:143], v56, s[16:19], s45 offen offset:3072 sc1
    s_add_u32 s45, s45, 4096
    s_cmp_eq_u32 s45, 28672
    s_cselect_b32 s45, 0, s45
    ds_read_b64_tr_b16 a[190:191], v15 offset:20992
    s_waitcnt vmcnt(8)
    ds_read_b64_tr_b16 a[192:193], v12 offset:24576
    ds_read_b64_tr_b16 a[194:195], v12 offset:25088
    ds_read_b64_tr_b16 a[196:197], v13 offset:24576
    buffer_load_dwordx4 v[144:147], v56, s[16:19], s45 offen offset:0 sc1
    ds_read_b64_tr_b16 a[198:199], v13 offset:25088
    ds_read_b64_tr_b16 a[200:201], v14 offset:24576
    ds_read_b64_tr_b16 a[202:203], v14 offset:25088
    ds_read_b64_tr_b16 a[204:205], v15 offset:24576
    buffer_load_dwordx4 v[148:151], v56, s[16:19], s45 offen offset:1024 sc1
    ds_read_b64_tr_b16 a[206:207], v15 offset:25088
    s_waitcnt vmcnt(6)
    ds_read_b64_tr_b16 a[208:209], v12 offset:28672
    ds_read_b64_tr_b16 a[210:211], v12 offset:29184
    ds_read_b64_tr_b16 a[212:213], v13 offset:28672
    buffer_load_dwordx4 v[152:155], v56, s[16:19], s45 offen offset:2048 sc1
    ds_read_b64_tr_b16 a[214:215], v13 offset:29184
    ds_read_b64_tr_b16 a[216:217], v14 offset:28672
    ds_read_b64_tr_b16 a[218:219], v14 offset:29184
    ds_read_b64_tr_b16 a[220:221], v15 offset:28672
    buffer_load_dwordx4 v[156:159], v56, s[16:19], s45 offen offset:3072 sc1
    s_add_u32 s45, s45, 4096
    s_cmp_eq_u32 s45, 28672
    s_cselect_b32 s45, 0, s45
    ds_read_b64_tr_b16 a[222:223], v15 offset:29184
    buffer_load_dwordx4 v[160:163], v56, s[16:19], s45 offen offset:0 sc1
    buffer_load_dwordx4 v[164:167], v56, s[16:19], s45 offen offset:1024 sc1
    buffer_load_dwordx4 v[168:171], v56, s[16:19], s45 offen offset:2048 sc1
    buffer_load_dwordx4 v[172:175], v56, s[16:19], s45 offen offset:3072 sc1
    s_add_u32 s45, s45, 4096
    s_cmp_eq_u32 s45, 28672
    s_cselect_b32 s45, 0, s45
    buffer_load_dwordx4 v[176:179], v56, s[16:19], s45 offen offset:0 sc1
    buffer_load_dwordx4 v[180:183], v56, s[16:19], s45 offen offset:1024 sc1
    s_waitcnt vmcnt(13)
    v_mfma_f32_16x16x32_bf16 v[64:67], v[128:131], a[0:3], 0
    s_waitcnt vmcnt(12)
    v_mfma_f32_16x16x32_bf16 v[68:71], v[132:135], a[0:3], 0
    v_mfma_f32_16x16x32_bf16 v[72:75], v[128:131], a[4:7], 0
    v_mfma_f32_16x16x32_bf16 v[76:79], v[132:135], a[4:7], 0
    v_mfma_f32_16x16x32_bf16 v[80:83], v[128:131], a[8:11], 0
    v_mfma_f32_16x16x32_bf16 v[84:87], v[132:135], a[8:11], 0
    v_mfma_f32_16x16x32_bf16 v[88:91], v[128:131], a[12:15], 0
    v_mfma_f32_16x16x32_bf16 v[92:95], v[132:135], a[12:15], 0
    s_waitcnt vmcnt(11)
    v_mfma_f32_16x16x32_bf16 v[64:67], v[136:139], a[16:19], v[64:67]
    buffer_load_dwordx4 v[128:131], v56, s[16:19], s45 offen offset:2048 sc1
    buffer_load_dword v34, v62, s[16:19], 0 offen sc1
    s_waitcnt vmcnt(12)
    v_mfma_f32_16x16x32_bf16 v[68:71], v[140:143], a[16:19], v[68:71]
    v_mfma_f32_16x16x32_bf16 v[72:75], v[136:139], a[20:23], v[72:75]
    v_mfma_f32_16x16x32_bf16 v[76:79], v[140:143], a[20:23], v[76:79]
    v_mfma_f32_16x16x32_bf16 v[80:83], v[136:139], a[24:27], v[80:83]
    buffer_load_dwordx4 v[132:135], v56, s[16:19], s45 offen offset:3072 sc1
    s_add_u32 s45, s45, 4096
    s_cmp_eq_u32 s45, 28672
    s_cselect_b32 s45, 0, s45
    v_mfma_f32_16x16x32_bf16 v[84:87], v[140:143], a[24:27], v[84:87]
    v_mfma_f32_16x16x32_bf16 v[88:91], v[136:139], a[28:31], v[88:91]
    v_mfma_f32_16x16x32_bf16 v[92:95], v[140:143], a[28:31], v[92:95]
    s_waitcnt vmcnt(12)
    v_mfma_f32_16x16x32_bf16 v[64:67], v[144:147], a[32:35], v[64:67]
    buffer_load_dwordx4 v[136:139], v56, s[16:19], s45 offen offset:0 sc1
    s_waitcnt vmcnt(12)
    v_mfma_f32_16x16x32_bf16 v[68:71], v[148:151], a[32:35], v[68:71]
    v_mfma_f32_16x16x32_bf16 v[72:75], v[144:147], a[36:39], v[72:75]
    v_mfma_f32_16x16x32_bf16 v[76:79], v[148:151], a[36:39], v[76:79]
    v_mfma_f32_16x16x32_bf16 v[80:83], v[144:147], a[40:43], v[80:83]
    buffer_load_dwordx4 v[140:143], v56, s[16:19], s45 offen offset:1024 sc1
    v_mfma_f32_16x16x32_bf16 v[84:87], v[148:151], a[40:43], v[84:87]
    v_mfma_f32_16x16x32_bf16 v[88:91], v[144:147], a[44:47], v[88:91]
    v_mfma_f32_16x16x32_bf16 v[92:95], v[148:151], a[44:47], v[92:95]
    s_waitcnt vmcnt(12)
    v_mfma_f32_16x16x32_bf16 v[64:67], v[152:155], a[48:51], v[64:67]
    buffer_load_dwordx4 v[144:147], v56, s[16:19], s45 offen offset:2048 sc1
    s_waitcnt vmcnt(12)
    v_mfma_f32_16x16x32_bf16 v[68:71], v[156:159], a[48:51], v[68:71]
    v_mfma_f32_16x16x32_bf16 v[72:75], v[152:155], a[52:55], v[72:75]
    v_mfma_f32_16x16x32_bf16 v[76:79], v[156:159], a[52:55], v[76:79]
    v_mfma_f32_16x16x32_bf16 v[80:83], v[152:155], a[56:59], v[80:83]
    buffer_load_dwordx4 v[148:151], v56, s[16:19], s45 offen offset:3072 sc1
    s_add_u32 s45, s45, 4096
    s_cmp_eq_u32 s45, 28672
    s_cselect_b32 s45, 0, s45
    v_mfma_f32_16x16x32_bf16 v[84:87], v[156:159], a[56:59], v[84:87]
    v_mfma_f32_16x16x32_bf16 v[88:91], v[152:155], a[60:63], v[88:91]
    v_mfma_f32_16x16x32_bf16 v[92:95], v[156:159], a[60:63], v[92:95]
    s_waitcnt vmcnt(12)
    v_mfma_f32_16x16x32_bf16 v[64:67], v[160:163], a[64:67], v[64:67]
    buffer_load_dwordx4 v[152:155], v56, s[16:19], s45 offen offset:0 sc1
    s_waitcnt vmcnt(12)
    v_mfma_f32_16x16x32_bf16 v[68:71], v[164:167], a[64:67], v[68:71]
    v_mfma_f32_16x16x32_bf16 v[72:75], v[160:163], a[68:71], v[72:75]
    v_mfma_f32_16x16x32_bf16 v[76:79], v[164:167], a[68:71], v[76:79]
    v_mfma_f32_16x16x32_bf16 v[80:83], v[160:163], a[72:75], v[80:83]
    buffer_load_dwordx4 v[156:159], v56, s[16:19], s45 offen offset:1024 sc1
    v_mfma_f32_16x16x32_bf16 v[84:87], v[164:167], a[72:75], v[84:87]
    v_mfma_f32_16x16x32_bf16 v[88:91], v[160:163], a[76:79], v[88:91]
    v_mfma_f32_16x16x32_bf16 v[92:95], v[164:167], a[76:79], v[92:95]
    s_waitcnt vmcnt(12)
    v_mfma_f32_16x16x32_bf16 v[64:67], v[168:171], a[80:83], v[64:67]
    buffer_load_dwordx4 v[160:163], v56, s[16:19], s45 offen offset:2048 sc1
    s_waitcnt vmcnt(12)
    v_mfma_f32_16x16x32_bf16 v[68:71], v[172:175], a[80:83], v[68:71]
    v_mfma_f32_16x16x32_bf16 v[72:75], v[168:171], a[84:87], v[72:75]
    v_mfma_f32_16x16x32_bf16 v[76:79], v[172:175], a[84:87], v[76:79]
    v_mfma_f32_16x16x32_bf16 v[80:83], v[168:171], a[88:91], v[80:83]
    buffer_load_dwordx4 v[164:167], v56, s[16:19], s45 offen offset:3072 sc1
    s_add_u32 s45, s45, 4096
    s_cmp_eq_u32 s45, 28672
    s_cselect_b32 s45, 0, s45
    v_mfma_f32_16x16x32_bf16 v[84:87], v[172:175], a[88:91], v[84:87]
    v_mfma_f32_16x16x32_bf16 v[88:91], v[168:171], a[92:95], v[88:91]
    v_mfma_f32_16x16x32_bf16 v[92:95], v[172:175], a[92:95], v[92:95]
    s_waitcnt vmcnt(12)
    v_mfma_f32_16x16x32_bf16 v[64:67], v[176:179], a[96:99], v[64:67]
    buffer_load_dwordx4 v[168:171], v56, s[16:19], s45 offen offset:0 sc1
    s_waitcnt vmcnt(12)
    v_mfma_f32_16x16x32_bf16 v[68:71], v[180:183], a[96:99], v[68:71]
    v_mfma_f32_16x16x32_bf16 v[72:75], v[176:179], a[100:103], v[72:75]
    v_mfma_f32_16x16x32_bf16 v[76:79], v[180:183], a[100:103], v[76:79]
    v_mfma_f32_16x16x32_bf16 v[80:83], v[176:179], a[104:107], v[80:83]
    buffer_load_dwordx4 v[172:175], v56, s[16:19], s45 offen offset:1024 sc1
    v_mfma_f32_16x16x32_bf16 v[84:87], v[180:183], a[104:107], v[84:87]
    v_mfma_f32_16x16x32_bf16 v[88:91], v[176:179], a[108:111], v[88:91]
    v_mfma_f32_16x16x32_bf16 v[92:95], v[180:183], a[108:111], v[92:95]
    s_waitcnt vmcnt(12)
    v_mfma_f32_16x16x32_bf16 v[64:67], v[128:131], a[112:115], v[64:67]
    buffer_load_dwordx4 v[176:179], v56, s[16:19], s45 offen offset:2048 sc1
    s_waitcnt vmcnt(11)
    v_mfma_f32_16x16x32_bf16 v[68:71], v[132:135], a[112:115], v[68:71]
    v_mfma_f32_16x16x32_bf16 v[72:75], v[128:131], a[116:119], v[72:75]
    v_mfma_f32_16x16x32_bf16 v[76:79], v[132:135], a[116:119], v[76:79]
    v_mfma_f32_16x16x32_bf16 v[80:83], v[128:131], a[120:123], v[80:83]
    buffer_load_dwordx4 v[180:183], v56, s[16:19], s45 offen offset:3072 sc1
    s_add_u32 s45, s45, 4096
    s_cmp_eq_u32 s45, 28672
    s_cselect_b32 s45, 0, s45
    v_mfma_f32_16x16x32_bf16 v[84:87], v[132:135], a[120:123], v[84:87]
    v_mfma_f32_16x16x32_bf16 v[88:91], v[128:131], a[124:127], v[88:91]
    v_mfma_f32_16x16x32_bf16 v[92:95], v[132:135], a[124:127], v[92:95]
    s_waitcnt vmcnt(11)
    v_mfma_f32_16x16x32_bf16 v[64:67], v[136:139], a[128:131], v[64:67]
    buffer_load_dwordx4 v[128:131], v57, s[16:19], s45 offen offset:0 sc1
    v_cmp_ne_u32 vcc, v34, v2
    s_cbranch_vccz L_fast_21
    s_mov_b32 s43, 200000
L_poll_22:
    buffer_load_dword v34, v62, s[16:19], 0 offen sc1
    s_waitcnt vmcnt(0)
    v_cmp_ne_u32 vcc, v34, v2
    s_cbranch_vccz L_polled_23
    s_sub_u32 s43, s43, 1
    s_cbranch_scc0 L_poll_22
L_polled_23:
L_fast_21:
    v_lshrrev_b32 v217, 8, v36
    v_and_b32 v217, 0x1ffc, v217
    v_sub_u32 v218, 8192, v217
    v_and_b32 v218, 0x1ffc, v218
    buffer_load_dword v217, v217, s[16:19], s89 offen sc1
    buffer_load_dword v218, v218, s[16:19], s89 offen sc1
    buffer_load_dword v212, v58, s[16:19], 0 offen sc1
    buffer_load_dword v213, v60, s[16:19], s84 offen sc1
    buffer_load_dword v214, v60, s[16:19], s85 offen sc1
    buffer_load_dword v215, v60, s[16:19], s86 offen sc1
    buffer_load_dword v216, v60, s[16:19], s87 offen sc1
    buffer_load_dword v224, v59, s[16:19], 0 offen sc1
    buffer_load_dword v225, v61, s[16:19], s84 offen sc1
    buffer_load_dword v226, v61, s[16:19], s85 offen sc1
    buffer_load_dword v227, v61, s[16:19], s86 offen sc1
    buffer_load_dword v228, v61, s[16:19], s87 offen sc1
    s_waitcnt vmcnt(23)
    v_mfma_f32_16x16x32_bf16 v[68:71], v[140:143], a[128:131], v[68:71]
    v_mfma_f32_16x16x32_bf16 v[72:75], v[136:139], a[132:135], v[72:75]
    v_mfma_f32_16x16x32_bf16 v[76:79], v[140:143], a[132:135], v[76:79]
    v_mfma_f32_16x16x32_bf16 v[80:83], v[136:139], a[136:139], v[80:83]
    buffer_load_dwordx4 v[132:135], v57, s[16:19], s45 offen offset:1024 sc1
    v_mfma_f32_16x16x32_bf16 v[84:87], v[140:143], a[136:139], v[84:87]
    v_mfma_f32_16x16x32_bf16 v[88:91], v[136:139], a[140:143], v[88:91]
    v_mfma_f32_16x16x32_bf16 v[92:95], v[140:143], a[140:143], v[92:95]
    s_waitcnt vmcnt(23)
    v_mfma_f32_16x16x32_bf16 v[64:67], v[144:147], a[144:147], v[64:67]
    buffer_load_dwordx4 v[136:139], v57, s[16:19], s45 offen offset:2048 sc1
    s_waitcnt vmcnt(23)
    v_mfma_f32_16x16x32_bf16 v[68:71], v[148:151], a[144:147], v[68:71]
    v_mfma_f32_16x16x32_bf16 v[72:75], v[144:147], a[148:151], v[72:75]
    v_mfma_f32_16x16x32_bf16 v[76:79], v[148:151], a[148:151], v[76:79]
    v_mfma_f32_16x16x32_bf16 v[80:83], v[144:147], a[152:155], v[80:83]
    buffer_load_dwordx4 v[140:143], v57, s[16:19], s45 offen offset:3072 sc1
    s_add_u32 s45, s45, 4096
    s_cmp_eq_u32 s45, 28672
    s_cselect_b32 s45, 0, s45
    v_mfma_f32_16x16x32_bf16 v[84:87], v[148:151], a[152:155], v[84:87]
    v_mfma_f32_16x16x32_bf16 v[88:91], v[144:147], a[156:159], v[88:91]
    v_mfma_f32_16x16x32_bf16 v[92:95], v[148:151], a[156:159], v[92:95]
    s_waitcnt vmcnt(23)
    v_mfma_f32_16x16x32_bf16 v[64:67], v[152:155], a[160:163], v[64:67]
    buffer_load_dwordx4 v[144:147], v57, s[16:19], s45 offen offset:0 sc1
    s_waitcnt vmcnt(23)
    v_mfma_f32_16x16x32_bf16 v[68:71], v[156:159], a[160:163], v[68:71]
    s_waitcnt lgkmcnt(15)
    v_mfma_f32_16x16x32_bf16 v[72:75], v[152:155], a[164:167], v[72:75]
    v_mfma_f32_16x16x32_bf16 v[76:79], v[156:159], a[164:167], v[76:79]
    v_mfma_f32_16x16x32_bf16 v[80:83], v[152:155], a[168:171], v[80:83]
    buffer_load_dwordx4 v[148:151], v57, s[16:19], s45 offen offset:1024 sc1
    v_mfma_f32_16x16x32_bf16 v[84:87], v[156:159], a[168:171], v[84:87]
    v_mfma_f32_16x16x32_bf16 v[88:91], v[152:155], a[172:175], v[88:91]
    v_mfma_f32_16x16x32_bf16 v[92:95], v[156:159], a[172:175], v[92:95]
    s_waitcnt vmcnt(23)
    v_mfma_f32_16x16x32_bf16 v[64:67], v[160:163], a[176:179], v[64:67]
    buffer_load_dwordx4 v[152:155], v57, s[16:19], s45 offen offset:2048 sc1
    s_waitcnt vmcnt(23)
    v_mfma_f32_16x16x32_bf16 v[68:71], v[164:167], a[176:179], v[68:71]
    v_mfma_f32_16x16x32_bf16 v[72:75], v[160:163], a[180:183], v[72:75]
    v_mfma_f32_16x16x32_bf16 v[76:79], v[164:167], a[180:183], v[76:79]
    v_mfma_f32_16x16x32_bf16 v[80:83], v[160:163], a[184:187], v[80:83]
    buffer_load_dwordx4 v[156:159], v57, s[16:19], s45 offen offset:3072 sc1
    s_add_u32 s45, s45, 4096
    s_cmp_eq_u32 s45, 28672
    s_cselect_b32 s45, 0, s45
    v_mfma_f32_16x16x32_bf16 v[84:87], v[164:167], a[184:187], v[84:87]
    v_mfma_f32_16x16x32_bf16 v[88:91], v[160:163], a[188:191], v[88:91]
    v_mfma_f32_16x16x32_bf16 v[92:95], v[164:167], a[188:191], v[92:95]
    s_waitcnt vmcnt(23) lgkmcnt(14)
    v_mfma_f32_16x16x32_bf16 v[64:67], v[168:171], a[192:195], v[64:67]
    buffer_load_dwordx4 v[160:163], v57, s[16:19], s45 offen offset:0 sc1
    s_waitcnt vmcnt(23)
    v_mfma_f32_16x16x32_bf16 v[68:71], v[172:175], a[192:195], v[68:71]
    s_waitcnt lgkmcnt(12)
    v_mfma_f32_16x16x32_bf16 v[72:75], v[168:171], a[196:199], v[72:75]
    v_mfma_f32_16x16x32_bf16 v[76:79], v[172:175], a[196:199], v[76:79]
    s_waitcnt lgkmcnt(10)
    v_mfma_f32_16x16x32_bf16 v[80:83], v[168:171], a[200:203], v[80:83]
    buffer_load_dwordx4 v[164:167], v57, s[16:19], s45 offen offset:1024 sc1
    v_mfma_f32_16x16x32_bf16 v[84:87], v[172:175], a[200:203], v[84:87]
    s_waitcnt lgkmcnt(8)
    v_mfma_f32_16x16x32_bf16 v[88:91], v[168:171], a[204:207], v[88:91]
    v_mfma_f32_16x16x32_bf16 v[92:95], v[172:175], a[204:207], v[92:95]
    s_waitcnt vmcnt(23) lgkmcnt(6)
    v_mfma_f32_16x16x32_bf16 v[64:67], v[176:179], a[208:211], v[64:67]
    buffer_load_dwordx4 v[168:171], v57, s[16:19], s45 offen offset:2048 sc1
    s_waitcnt vmcnt(18)
    v_bfi_b32 v212, s88, v212, v213
    s_waitcnt vmcnt(17)
    v_bfi_b32 v213, s88, v213, v214
    s_waitcnt vmcnt(16)
    v_bfi_b32 v214, s88, v214, v215
    s_waitcnt vmcnt(15)
    v_bfi_b32 v215, s88, v215, v216
    v_lshlrev_b32 v192, 16, v212
    v_and_b32 v193, 0xffff0000, v212
    v_mfma_f32_16x16x32_bf16 v[68:71], v[180:183], a[208:211], v[68:71]
    v_lshlrev_b32 v194, 16, v213
    v_and_b32 v195, 0xffff0000, v213
    s_waitcnt lgkmcnt(4)
    v_mfma_f32_16x16x32_bf16 v[72:75], v[176:179], a[212:215], v[72:75]
    v_lshlrev_b32 v196, 16, v214
    v_and_b32 v197, 0xffff0000, v214
    v_mfma_f32_16x16x32_bf16 v[76:79], v[180:183], a[212:215], v[76:79]
    v_lshlrev_b32 v198, 16, v215
    v_and_b32 v199, 0xffff0000, v215
    s_waitcnt lgkmcnt(2)
    v_mfma_f32_16x16x32_bf16 v[80:83], v[176:179], a[216:219], v[80:83]
    buffer_load_dwordx4 v[172:175], v57, s[16:19], s45 offen offset:3072 sc1
    s_add_u32 s45, s45, 4096
    s_cmp_eq_u32 s45, 28672
    s_cselect_b32 s45, 0, s45
    v_lshlrev_b32 v200, 16, v208
    v_and_b32 v201, 0xffff0000, v208
    v_mfma_f32_16x16x32_bf16 v[84:87], v[180:183], a[216:219], v[84:87]
    v_lshlrev_b32 v202, 16, v209
    v_and_b32 v203, 0xffff0000, v209
    s_waitcnt lgkmcnt(0)
    v_mfma_f32_16x16x32_bf16 v[88:91], v[176:179], a[220:223], v[88:91]
    v_lshlrev_b32 v204, 16, v210
    v_and_b32 v205, 0xffff0000, v210
    v_mfma_f32_16x16x32_bf16 v[92:95], v[180:183], a[220:223], v[92:95]
    v_lshlrev_b32 v206, 16, v211
    v_and_b32 v207, 0xffff0000, v211
    v_mfma_f32_16x16x32_bf16 v[96:99], v[128:131], a[0:3], 0
    buffer_load_dwordx4 v[176:179], v57, s[16:19], s45 offen offset:0 sc1
    v_lshlrev_b32 v217, s3, v217
    v_lshlrev_b32 v218, s3, v218
    s_waitcnt vmcnt(11)
    v_mfma_f32_16x16x32_bf16 v[100:103], v[132:135], a[0:3], 0
    v_add_f32 v217, v217, v218
    v_mul_f32 v217, 0.5, v217
    v_mfma_f32_16x16x32_bf16 v[104:107], v[128:131], a[4:7], 0
    v_cvt_pk_bf16_f32 v217, 0, v217
    v_cndmask_b32 v192, v192, v217, s[90:91]
    v_mfma_f32_16x16x32_bf16 v[108:111], v[132:135], a[4:7], 0
    v_bfi_b32 v224, s88, v224, v225
    v_bfi_b32 v225, s88, v225, v226
    v_mfma_f32_16x16x32_bf16 v[112:115], v[128:131], a[8:11], 0
    buffer_load_dwordx4 v[180:183], v57, s[16:19], s45 offen offset:1024 sc1
    v_bfi_b32 v226, s88, v226, v227
    v_bfi_b32 v227, s88, v227, v228
    v_mfma_f32_16x16x32_bf16 v[116:119], v[132:135], a[8:11], 0
    v_lshlrev_b32 v40, 16, v224
    v_and_b32 v41, 0xffff0000, v224
    v_mfma_f32_16x16x32_bf16 v[120:123], v[128:131], a[12:15], 0
    v_lshlrev_b32 v42, 16, v225
    v_and_b32 v43, 0xffff0000, v225
    v_mfma_f32_16x16x32_bf16 v[124:127], v[132:135], a[12:15], 0
    v_lshlrev_b32 v44, 16, v226
    v_and_b32 v45, 0xffff0000, v226
    s_waitcnt vmcnt(11)
    v_mfma_f32_16x16x32_bf16 v[96:99], v[136:139], a[16:19], v[96:99]
    buffer_load_dwordx4 v[128:131], v57, s[16:19], s45 offen offset:2048 sc1
    v_lshlrev_b32 v46, 16, v227
    v_and_b32 v47, 0xffff0000, v227
    s_waitcnt vmcnt(11)
    v_mfma_f32_16x16x32_bf16 v[100:103], v[140:143], a[16:19], v[100:103]
    v_lshlrev_b32 v48, 16, v220
    v_and_b32 v49, 0xffff0000, v220
    v_mfma_f32_16x16x32_bf16 v[104:107], v[136:139], a[20:23], v[104:107]
    v_lshlrev_b32 v50, 16, v221
    v_and_b32 v51, 0xffff0000, v221
    v_mfma_f32_16x16x32_bf16 v[108:111], v[140:143], a[20:23], v[108:111]
    v_lshlrev_b32 v52, 16, v222
    v_and_b32 v53, 0xffff0000, v222
    v_mfma_f32_16x16x32_bf16 v[112:115], v[136:139], a[24:27], v[112:115]
    buffer_load_dwordx4 v[132:135], v57, s[16:19], s45 offen offset:3072 sc1
    s_add_u32 s45, s45, 4096
    s_cmp_eq_u32 s45, 28672
    s_cselect_b32 s45, 0, s45
    v_lshlrev_b32 v54, 16, v223
    v_and_b32 v55, 0xffff0000, v223
    v_mfma_f32_16x16x32_bf16 v[116:119], v[140:143], a[24:27], v[116:119]
    v_mfma_f32_16x16x32_bf16 v[120:123], v[136:139], a[28:31], v[120:123]
    v_mfma_f32_16x16x32_bf16 v[124:127], v[140:143], a[28:31], v[124:127]
    ds_write_b128 v20, v[72:75] offset:0
    s_waitcnt vmcnt(11)
    v_mfma_f32_16x16x32_bf16 v[96:99], v[144:147], a[32:35], v[96:99]
    buffer_load_dwordx4 v[136:139], v57, s[16:19], s45 offen offset:0 sc1
    s_waitcnt vmcnt(11)
    v_mfma_f32_16x16x32_bf16 v[100:103], v[148:151], a[32:35], v[100:103]
    v_mfma_f32_16x16x32_bf16 v[104:107], v[144:147], a[36:39], v[104:107]
    ds_write_b128 v20, v[76:79] offset:1024
    v_mfma_f32_16x16x32_bf16 v[108:111], v[148:151], a[36:39], v[108:111]
    v_mfma_f32_16x16x32_bf16 v[112:115], v[144:147], a[40:43], v[112:115]
    buffer_load_dwordx4 v[140:143], v57, s[16:19], s45 offen offset:1024 sc1
    v_mfma_f32_16x16x32_bf16 v[116:119], v[148:151], a[40:43], v[116:119]
    ds_write_b128 v21, v[80:83] offset:0
    v_mfma_f32_16x16x32_bf16 v[120:123], v[144:147], a[44:47], v[120:123]
    v_mfma_f32_16x16x32_bf16 v[124:127], v[148:151], a[44:47], v[124:127]
    s_waitcnt vmcnt(11)
    v_mfma_f32_16x16x32_bf16 v[96:99], v[152:155], a[48:51], v[96:99]
    buffer_load_dwordx4 v[144:147], v57, s[16:19], s45 offen offset:2048 sc1
    ds_write_b128 v21, v[84:87] offset:1024
    s_waitcnt vmcnt(11)
    v_mfma_f32_16x16x32_bf16 v[100:103], v[156:159], a[48:51], v[100:103]
    v_mfma_f32_16x16x32_bf16 v[104:107], v[152:155], a[52:55], v[104:107]
    v_mfma_f32_16x16x32_bf16 v[108:111], v[156:159], a[52:55], v[108:111]
    ds_write_b128 v22, v[88:91] offset:0
    v_mfma_f32_16x16x32_bf16 v[112:115], v[152:155], a[56:59], v[112:115]
    buffer_load_dwordx4 v[148:151], v57, s[16:19], s45 offen offset:3072 sc1
    s_add_u32 s45, s45, 4096
    s_cmp_eq_u32 s45, 28672
    s_cselect_b32 s45, 0, s45
    v_mfma_f32_16x16x32_bf16 v[116:119], v[156:159], a[56:59], v[116:119]
    v_mfma_f32_16x16x32_bf16 v[120:123], v[152:155], a[60:63], v[120:123]
    ds_write_b128 v22, v[92:95] offset:1024
    v_mfma_f32_16x16x32_bf16 v[124:127], v[156:159], a[60:63], v[124:127]
    s_waitcnt vmcnt(11)
    v_mfma_f32_16x16x32_bf16 v[96:99], v[160:163], a[64:67], v[96:99]
    buffer_load_dwordx4 v[152:155], v57, s[16:19], s45 offen offset:0 sc1
    s_waitcnt vmcnt(11)
    v_mfma_f32_16x16x32_bf16 v[100:103], v[164:167], a[64:67], v[100:103]
    s_waitcnt lgkmcnt(0)
    v_mfma_f32_16x16x32_bf16 v[104:107], v[160:163], a[68:71], v[104:107]
    v_mfma_f32_16x16x32_bf16 v[108:111], v[164:167], a[68:71], v[108:111]
    s_barrier
    v_mfma_f32_16x16x32_bf16 v[112:115], v[160:163], a[72:75], v[112:115]
    buffer_load_dwordx4 v[156:159], v57, s[16:19], s45 offen offset:1024 sc1
    ds_read_b128 v[72:75], v23 offset:0
    v_mfma_f32_16x16x32_bf16 v[116:119], v[164:167], a[72:75], v[116:119]
    v_mfma_f32_16x16x32_bf16 v[120:123], v[160:163], a[76:79], v[120:123]
    ds_read_b128 v[76:79], v23 offset:1024
    v_mfma_f32_16x16x32_bf16 v[124:127], v[164:167], a[76:79], v[124:127]
    ds_read_b128 v[80:83], v23 offset:2048
    s_waitcnt vmcnt(11)
    v_mfma_f32_16x16x32_bf16 v[96:99], v[168:171], a[80:83], v[96:99]
    buffer_load_dwordx4 v[160:163], v57, s[16:19], s45 offen offset:2048 sc1
    s_waitcnt vmcnt(11)
    v_mfma_f32_16x16x32_bf16 v[100:103], v[172:175], a[80:83], v[100:103]
    ds_read_b128 v[84:87], v23 offset:3072
    v_mfma_f32_16x16x32_bf16 v[104:107], v[168:171], a[84:87], v[104:107]
    ds_read_b128 v[88:91], v23 offset:4096
    v_mfma_f32_16x16x32_bf16 v[108:111], v[172:175], a[84:87], v[108:111]
    v_mfma_f32_16x16x32_bf16 v[112:115], v[168:171], a[88:91], v[112:115]
    buffer_load_dwordx4 v[164:167], v57, s[16:19], s45 offen offset:3072 sc1
    s_add_u32 s45, s45, 4096
    s_cmp_eq_u32 s45, 28672
    s_cselect_b32 s45, 0, s45
    ds_read_b128 v[92:95], v23 offset:5120
    v_mfma_f32_16x16x32_bf16 v[116:119], v[172:175], a[88:91], v[116:119]
    v_mfma_f32_16x16x32_bf16 v[120:123], v[168:171], a[92:95], v[120:123]
    v_mfma_f32_16x16x32_bf16 v[124:127], v[172:175], a[92:95], v[124:127]
    s_waitcnt vmcnt(11)
    v_mfma_f32_16x16x32_bf16 v[96:99], v[176:179], a[96:99], v[96:99]
    buffer_load_dwordx4 v[168:171], v57, s[16:19], s45 offen offset:0 sc1
    s_waitcnt vmcnt(11)
    v_mfma_f32_16x16x32_bf16 v[100:103], v[180:183], a[96:99], v[100:103]
    v_mfma_f32_16x16x32_bf16 v[104:107], v[176:179], a[100:103], v[104:107]
    v_mfma_f32_16x16x32_bf16 v[108:111], v[180:183], a[100:103], v[108:111]
    s_waitcnt lgkmcnt(5)
    v_add_f32 v64, v64, v72
    v_add_f32 v65, v65, v73
    v_mfma_f32_16x16x32_bf16 v[112:115], v[176:179], a[104:107], v[112:115]
    buffer_load_dwordx4 v[172:175], v57, s[16:19], s45 offen offset:1024 sc1
    v_add_f32 v66, v66, v74
    v_add_f32 v67, v67, v75
    v_mfma_f32_16x16x32_bf16 v[116:119], v[180:183], a[104:107], v[116:119]
    s_waitcnt lgkmcnt(4)
    v_add_f32 v68, v68, v76
    v_add_f32 v69, v69, v77
    v_mfma_f32_16x16x32_bf16 v[120:123], v[176:179], a[108:111], v[120:123]
    v_add_f32 v70, v70, v78
    v_add_f32 v71, v71, v79
    v_mfma_f32_16x16x32_bf16 v[124:127], v[180:183], a[108:111], v[124:127]
    s_waitcnt lgkmcnt(1)
    v_add_f32 v80, v80, v88
    v_add_f32 v81, v81, v89
    s_waitcnt vmcnt(11)
    v_mfma_f32_16x16x32_bf16 v[96:99], v[128:131], a[112:115], v[96:99]
    buffer_load_dwordx4 v[176:179], v57, s[16:19], s45 offen offset:2048 sc1
    v_add_f32 v82, v82, v90
    v_add_f32 v83, v83, v91
    s_waitcnt vmcnt(11)
    v_mfma_f32_16x16x32_bf16 v[100:103], v[132:135], a[112:115], v[100:103]
    s_waitcnt lgkmcnt(0)
    v_add_f32 v84, v84, v92
    v_add_f32 v85, v85, v93
    v_mfma_f32_16x16x32_bf16 v[104:107], v[128:131], a[116:119], v[104:107]
    v_add_f32 v86, v86, v94
    v_add_f32 v87, v87, v95
    v_mfma_f32_16x16x32_bf16 v[108:111], v[132:135], a[116:119], v[108:111]
    v_add_f32 v64, v64, v80
    v_add_f32 v65, v65, v81
    v_mfma_f32_16x16x32_bf16 v[112:115], v[128:131], a[120:123], v[112:115]
    buffer_load_dwordx4 v[180:183], v57, s[16:19], s45 offen offset:3072 sc1
    s_add_u32 s45, s45, 4096
    s_cmp_eq_u32 s45, 28672
    s_cselect_b32 s45, 0, s45
    v_add_f32 v66, v66, v82
    v_add_f32 v67, v67, v83
    v_mfma_f32_16x16x32_bf16 v[116:119], v[132:135], a[120:123], v[116:119]
    v_add_f32 v68, v68, v84
    v_add_f32 v69, v69, v85
    v_mfma_f32_16x16x32_bf16 v[120:123], v[128:131], a[124:127], v[120:123]
    v_add_f32 v70, v70, v86
    v_add_f32 v71, v71, v87
    v_mfma_f32_16x16x32_bf16 v[124:127], v[132:135], a[124:127], v[124:127]
    s_waitcnt vmcnt(11)
    v_mfma_f32_16x16x32_bf16 v[104:107], v[136:139], a[132:135], v[104:107]
    s_barrier
    v_cvt_pk_bf16_f32 v64, 0, v64
    v_cvt_pk_bf16_f32 v65, 0, v65
    s_waitcnt vmcnt(10)
    v_mfma_f32_16x16x32_bf16 v[108:111], v[140:143], a[132:135], v[108:111]
    v_cvt_pk_bf16_f32 v66, 0, v66
    v_cvt_pk_bf16_f32 v67, 0, v67
    v_cvt_pk_bf16_f32 v68, 0, v68
    v_mfma_f32_16x16x32_bf16 v[112:115], v[136:139], a[136:139], v[112:115]
    v_cvt_pk_bf16_f32 v69, 0, v69
    v_cvt_pk_bf16_f32 v70, 0, v70
    v_cvt_pk_bf16_f32 v71, 0, v71
    v_mfma_f32_16x16x32_bf16 v[116:119], v[140:143], a[136:139], v[116:119]
    v_add_f32 v64, v64, v37
    v_add_f32 v65, v65, v37
    v_add_f32 v66, v66, v37
    v_mfma_f32_16x16x32_bf16 v[120:123], v[136:139], a[140:143], v[120:123]
    v_add_f32 v67, v67, v37
    v_add_f32 v68, v68, v37
    v_add_f32 v69, v69, v37
    v_mfma_f32_16x16x32_bf16 v[124:127], v[140:143], a[140:143], v[124:127]
    v_add_f32 v70, v70, v37
    v_add_f32 v71, v71, v37
    v_cvt_pk_bf16_f32 v64, 0, v64
    s_waitcnt vmcnt(9)
    v_mfma_f32_16x16x32_bf16 v[104:107], v[144:147], a[148:151], v[104:107]
    v_cvt_pk_bf16_f32 v65, 0, v65
    v_cvt_pk_bf16_f32 v66, 0, v66
    v_cvt_pk_bf16_f32 v67, 0, v67
    s_waitcnt vmcnt(8)
    v_mfma_f32_16x16x32_bf16 v[108:111], v[148:151], a[148:151], v[108:111]
    v_cvt_pk_bf16_f32 v68, 0, v68
    v_cvt_pk_bf16_f32 v69, 0, v69
    v_cvt_pk_bf16_f32 v70, 0, v70
    v_mfma_f32_16x16x32_bf16 v[112:115], v[144:147], a[152:155], v[112:115]
    v_cvt_pk_bf16_f32 v71, 0, v71
    v_mul_f32 v72, 0xbfb8aa3b, v64
    v_mul_f32 v73, 0xbfb8aa3b, v65
    v_mfma_f32_16x16x32_bf16 v[116:119], v[148:151], a[152:155], v[116:119]
    v_mul_f32 v74, 0xbfb8aa3b, v66
    v_mul_f32 v75, 0xbfb8aa3b, v67
    v_mul_f32 v76, 0xbfb8aa3b, v68
    v_mfma_f32_16x16x32_bf16 v[120:123], v[144:147], a[156:159], v[120:123]
    v_mul_f32 v77, 0xbfb8aa3b, v69
    v_mul_f32 v78, 0xbfb8aa3b, v70
    v_mul_f32 v79, 0xbfb8aa3b, v71
    v_mfma_f32_16x16x32_bf16 v[124:127], v[148:151], a[156:159], v[124:127]
    v_exp_f32 v72, v72
    s_waitcnt vmcnt(7)
    v_mfma_f32_16x16x32_bf16 v[104:107], v[152:155], a[164:167], v[104:107]
    v_exp_f32 v73, v73
    v_exp_f32 v74, v74
    s_waitcnt vmcnt(6)
    v_mfma_f32_16x16x32_bf16 v[108:111], v[156:159], a[164:167], v[108:111]
    v_exp_f32 v75, v75
    v_mfma_f32_16x16x32_bf16 v[112:115], v[152:155], a[168:171], v[112:115]
    v_exp_f32 v76, v76
    v_exp_f32 v77, v77
    v_mfma_f32_16x16x32_bf16 v[116:119], v[156:159], a[168:171], v[116:119]
    v_exp_f32 v78, v78
    v_mfma_f32_16x16x32_bf16 v[120:123], v[152:155], a[172:175], v[120:123]
    v_exp_f32 v79, v79
    v_add_f32 v72, 1.0, v72
    v_add_f32 v73, 1.0, v73
    v_mfma_f32_16x16x32_bf16 v[124:127], v[156:159], a[172:175], v[124:127]
    v_add_f32 v74, 1.0, v74
    v_add_f32 v75, 1.0, v75
    v_add_f32 v76, 1.0, v76
    s_waitcnt vmcnt(5)
    v_mfma_f32_16x16x32_bf16 v[104:107], v[160:163], a[180:183], v[104:107]
    v_add_f32 v77, 1.0, v77
    v_add_f32 v78, 1.0, v78
    v_add_f32 v79, 1.0, v79
    s_waitcnt vmcnt(4)
    v_mfma_f32_16x16x32_bf16 v[108:111], v[164:167], a[180:183], v[108:111]
    v_rcp_f32 v72, v72
    v_mfma_f32_16x16x32_bf16 v[112:115], v[160:163], a[184:187], v[112:115]
    v_rcp_f32 v73, v73
    v_rcp_f32 v74, v74
    v_mfma_f32_16x16x32_bf16 v[116:119], v[164:167], a[184:187], v[116:119]
    v_rcp_f32 v75, v75
    v_mfma_f32_16x16x32_bf16 v[120:123], v[160:163], a[188:191], v[120:123]
    v_rcp_f32 v76, v76
    v_rcp_f32 v77, v77
    v_mfma_f32_16x16x32_bf16 v[124:127], v[164:167], a[188:191], v[124:127]
    v_rcp_f32 v78, v78
    s_waitcnt vmcnt(3)
    v_mfma_f32_16x16x32_bf16 v[104:107], v[168:171], a[196:199], v[104:107]
    v_rcp_f32 v79, v79
    v_mul_f32 v64, v64, v72
    v_mul_f32 v65, v65, v73
    s_waitcnt vmcnt(2)
    v_mfma_f32_16x16x32_bf16 v[108:111], v[172:175], a[196:199], v[108:111]
    v_mul_f32 v66, v66, v74
    v_mul_f32 v67, v67, v75
    v_mul_f32 v68, v68, v76
    v_mfma_f32_16x16x32_bf16 v[112:115], v[168:171], a[200:203], v[112:115]
    v_mul_f32 v69, v69, v77
    v_mul_f32 v70, v70, v78
    v_mul_f32 v71, v71, v79
    v_mfma_f32_16x16x32_bf16 v[116:119], v[172:175], a[200:203], v[116:119]
    v_cvt_pk_bf16_f32 v64, 0, v64
    v_cvt_pk_bf16_f32 v65, 0, v65
    v_cvt_pk_bf16_f32 v66, 0, v66
    v_mfma_f32_16x16x32_bf16 v[120:123], v[168:171], a[204:207], v[120:123]
    v_cvt_pk_bf16_f32 v67, 0, v67
    v_cvt_pk_bf16_f32 v68, 0, v68
    v_cvt_pk_bf16_f32 v69, 0, v69
    v_mfma_f32_16x16x32_bf16 v[124:127], v[172:175], a[204:207], v[124:127]
    v_cvt_pk_bf16_f32 v70, 0, v70
    v_cvt_pk_bf16_f32 v71, 0, v71
    v_mul_f32 v64, v64, v192
    s_waitcnt vmcnt(1)
    v_mfma_f32_16x16x32_bf16 v[104:107], v[176:179], a[212:215], v[104:107]
    v_mul_f32 v65, v65, v193
    v_mul_f32 v66, v66, v194
    v_mul_f32 v67, v67, v195
    s_waitcnt vmcnt(0)
    v_mfma_f32_16x16x32_bf16 v[108:111], v[180:183], a[212:215], v[108:111]
    v_mul_f32 v68, v68, v196
    v_mul_f32 v69, v69, v197
    v_mul_f32 v70, v70, v198
    v_mfma_f32_16x16x32_bf16 v[112:115], v[176:179], a[216:219], v[112:115]
    v_mul_f32 v71, v71, v199
    v_cvt_pk_bf16_f32 v64, 0, v64
    v_cvt_pk_bf16_f32 v65, 0, v65
    v_mfma_f32_16x16x32_bf16 v[116:119], v[180:183], a[216:219], v[116:119]
    v_cvt_pk_bf16_f32 v66, 0, v66
    v_cvt_pk_bf16_f32 v67, 0, v67
    v_cvt_pk_bf16_f32 v68, 0, v68
    v_mfma_f32_16x16x32_bf16 v[120:123], v[176:179], a[220:223], v[120:123]
    v_cvt_pk_bf16_f32 v69, 0, v69
    v_cvt_pk_bf16_f32 v70, 0, v70
    v_cvt_pk_bf16_f32 v71, 0, v71
    v_mfma_f32_16x16x32_bf16 v[124:127], v[180:183], a[220:223], v[124:127]
    v_add_f32 v64, v64, v200
    v_add_f32 v65, v65, v201
    v_add_f32 v66, v66, v202
    v_mfma_f32_16x16x32_bf16 v[96:99], v[136:139], a[128:131], v[96:99]
    v_mfma_f32_16x16x32_bf16 v[100:103], v[140:143], a[128:131], v[100:103]
    ds_write_b128 v20, v[104:107] offset:0
    v_mfma_f32_16x16x32_bf16 v[96:99], v[144:147], a[144:147], v[96:99]
    v_mfma_f32_16x16x32_bf16 v[100:103], v[148:151], a[144:147], v[100:103]
    ds_write_b128 v20, v[108:111] offset:1024
    v_mfma_f32_16x16x32_bf16 v[96:99], v[152:155], a[160:163], v[96:99]
    v_mfma_f32_16x16x32_bf16 v[100:103], v[156:159], a[160:163], v[100:103]
    ds_write_b128 v21, v[112:115] offset:0
    v_mfma_f32_16x16x32_bf16 v[96:99], v[160:163], a[176:179], v[96:99]
    v_mfma_f32_16x16x32_bf16 v[100:103], v[164:167], a[176:179], v[100:103]
    ds_write_b128 v21, v[116:119] offset:1024
    v_mfma_f32_16x16x32_bf16 v[96:99], v[168:171], a[192:195], v[96:99]
    v_mfma_f32_16x16x32_bf16 v[100:103], v[172:175], a[192:195], v[100:103]
    ds_write_b128 v22, v[120:123] offset:0
    v_mfma_f32_16x16x32_bf16 v[96:99], v[176:179], a[208:211], v[96:99]
    v_mfma_f32_16x16x32_bf16 v[100:103], v[180:183], a[208:211], v[100:103]
    ds_write_b128 v22, v[124:127] offset:1024
    v_add_f32 v67, v67, v203
    v_add_f32 v68, v68, v204
    v_add_f32 v69, v69, v205
    v_add_f32 v70, v70, v206
    v_add_f32 v71, v71, v207
    v_cvt_pk_bf16_f32 v208, v64, v65
    v_cvt_pk_bf16_f32 v209, v66, v67
    v_cvt_pk_bf16_f32 v210, v68, v69
    v_cvt_pk_bf16_f32 v211, v70, v71
    buffer_store_dwordx4 v[208:211], v36, s[20:23], 0 offen offset:0 sc1 nt
    s_waitcnt lgkmcnt(0)
    s_barrier
    ds_read_b128 v[104:107], v23 offset:0
    ds_read_b128 v[108:111], v23 offset:1024
    ds_read_b128 v[112:115], v23 offset:2048
    ds_read_b128 v[116:119], v23 offset:3072
    ds_read_b128 v[120:123], v23 offset:4096
    ds_read_b128 v[124:127], v23 offset:5120
    s_waitcnt lgkmcnt(5)
    v_pk_add_f32 v[96:97], v[96:97], v[104:105]
    v_pk_add_f32 v[98:99], v[98:99], v[106:107]
    s_waitcnt lgkmcnt(4)
    v_pk_add_f32 v[100:101], v[100:101], v[108:109]
    v_pk_add_f32 v[102:103], v[102:103], v[110:111]
    s_waitcnt lgkmcnt(1)
    v_pk_add_f32 v[112:113], v[112:113], v[120:121]
    v_pk_add_f32 v[114:115], v[114:115], v[122:123]
    s_waitcnt lgkmcnt(0)
    v_pk_add_f32 v[116:117], v[116:117], v[124:125]
    v_pk_add_f32 v[118:119], v[118:119], v[126:127]
    v_pk_add_f32 v[96:97], v[96:97], v[112:113]
    v_pk_add_f32 v[98:99], v[98:99], v[114:115]
    v_pk_add_f32 v[100:101], v[100:101], v[116:117]
    v_pk_add_f32 v[102:103], v[102:103], v[118:119]
    v_cvt_pk_bf16_f32 v96, 0, v96
    v_cvt_pk_bf16_f32 v97, 0, v97
    v_cvt_pk_bf16_f32 v98, 0, v98
    v_cvt_pk_bf16_f32 v99, 0, v99
    v_cvt_pk_bf16_f32 v100, 0, v100
    v_cvt_pk_bf16_f32 v101, 0, v101
    v_cvt_pk_bf16_f32 v102, 0, v102
    v_cvt_pk_bf16_f32 v103, 0, v103
    v_pk_add_f32 v[96:97], v[96:97], v[36:37] op_sel:[0,1] op_sel_hi:[1,1]
    v_pk_add_f32 v[98:99], v[98:99], v[36:37] op_sel:[0,1] op_sel_hi:[1,1]
    v_pk_add_f32 v[100:101], v[100:101], v[36:37] op_sel:[0,1] op_sel_hi:[1,1]
    v_pk_add_f32 v[102:103], v[102:103], v[36:37] op_sel:[0,1] op_sel_hi:[1,1]
    s_mov_b32 s80, 0xbfb8aa3b
    v_cvt_pk_bf16_f32 v96, 0, v96
    v_cvt_pk_bf16_f32 v97, 0, v97
    v_cvt_pk_bf16_f32 v98, 0, v98
    v_cvt_pk_bf16_f32 v99, 0, v99
    v_cvt_pk_bf16_f32 v100, 0, v100
    v_cvt_pk_bf16_f32 v101, 0, v101
    v_cvt_pk_bf16_f32 v102, 0, v102
    v_cvt_pk_bf16_f32 v103, 0, v103
    v_pk_mul_f32 v[104:105], v[96:97], s[80:81] op_sel_hi:[1,0]
    v_pk_mul_f32 v[106:107], v[98:99], s[80:81] op_sel_hi:[1,0]
    v_pk_mul_f32 v[108:109], v[100:101], s[80:81] op_sel_hi:[1,0]
    v_pk_mul_f32 v[110:111], v[102:103], s[80:81] op_sel_hi:[1,0]
    v_exp_f32 v104, v104
    v_exp_f32 v105, v105
    v_exp_f32 v106, v106
    v_exp_f32 v107, v107
    v_exp_f32 v108, v108
    v_exp_f32 v109, v109
    v_exp_f32 v110, v110
    v_exp_f32 v111, v111
    v_pk_add_f32 v[104:105], v[104:105], 1.0 op_sel_hi:[1,0]
    v_pk_add_f32 v[106:107], v[106:107], 1.0 op_sel_hi:[1,0]
    v_pk_add_f32 v[108:109], v[108:109], 1.0 op_sel_hi:[1,0]
    v_pk_add_f32 v[110:111], v[110:111], 1.0 op_sel_hi:[1,0]
    v_rcp_f32 v104, v104
    v_rcp_f32 v105, v105
    v_rcp_f32 v106, v106
    v_rcp_f32 v107, v107
    v_rcp_f32 v108, v108
    v_rcp_f32 v109, v109
    v_rcp_f32 v110, v110
    v_rcp_f32 v111, v111
    v_pk_mul_f32 v[96:97], v[96:97], v[104:105]
    v_pk_mul_f32 v[98:99], v[98:99], v[106:107]
    v_pk_mul_f32 v[100:101], v[100:101], v[108:109]
    v_pk_mul_f32 v[102:103], v[102:103], v[110:111]
    v_cvt_pk_bf16_f32 v96, 0, v96
    v_cvt_pk_bf16_f32 v97, 0, v97
    v_cvt_pk_bf16_f32 v98, 0, v98
    v_cvt_pk_bf16_f32 v99, 0, v99
    v_cvt_pk_bf16_f32 v100, 0, v100
    v_cvt_pk_bf16_f32 v101, 0, v101
    v_cvt_pk_bf16_f32 v102, 0, v102
    v_cvt_pk_bf16_f32 v103, 0, v103
    v_pk_mul_f32 v[96:97], v[96:97], v[40:41]
    v_pk_mul_f32 v[98:99], v[98:99], v[42:43]
    v_pk_mul_f32 v[100:101], v[100:101], v[44:45]
    v_pk_mul_f32 v[102:103], v[102:103], v[46:47]
    v_cvt_pk_bf16_f32 v96, 0, v96
    v_cvt_pk_bf16_f32 v97, 0, v97
    v_cvt_pk_bf16_f32 v98, 0, v98
    v_cvt_pk_bf16_f32 v99, 0, v99
    v_cvt_pk_bf16_f32 v100, 0, v100
    v_cvt_pk_bf16_f32 v101, 0, v101
    v_cvt_pk_bf16_f32 v102, 0, v102
    v_cvt_pk_bf16_f32 v103, 0, v103
    v_pk_add_f32 v[96:97], v[96:97], v[48:49]
    v_pk_add_f32 v[98:99], v[98:99], v[50:51]
    v_pk_add_f32 v[100:101], v[100:101], v[52:53]
    v_pk_add_f32 v[102:103], v[102:103], v[54:55]
    v_cvt_pk_bf16_f32 v220, v96, v97
    v_cvt_pk_bf16_f32 v221, v98, v99
    v_cvt_pk_bf16_f32 v222, v100, v101
    v_cvt_pk_bf16_f32 v223, v102, v103
    buffer_store_dwordx4 v[220:223], v36, s[20:23], 0 offen offset:64 sc1 nt
    s_endpgm
L_end:
    s_endpgm
L_code_end:
.section .rodata,"a"
.p2align 6
.amdhsa_kernel recurrent_scan__spectral_fnet__mixer_token_mlp__prompt_kernel
  .amdhsa_next_free_vgpr 512
  .amdhsa_next_free_sgpr 102
  .amdhsa_accum_offset 256
  .amdhsa_group_segment_fixed_size 0
  .amdhsa_kernarg_size 104
  .amdhsa_user_sgpr_count 2
  .amdhsa_user_sgpr_kernarg_segment_ptr 1
  .amdhsa_system_sgpr_workgroup_id_x 1
.end_amdhsa_kernel
```
